```python
import torch

def _softmax(x, axis=-1):
    return torch.softmax(x, dim=axis)

def _gelu(x):
    return torch.nn.functional.gelu(x, approximate='tanh')

def _silu(x):
    return torch.nn.functional.silu(x)

def _sigmoid(x):
    return torch.sigmoid(x)

def _layernorm(x, axis=-1, eps=1e-05):
    m = x.mean(dim=axis, keepdim=True)
    v = x.var(dim=axis, keepdim=True, unbiased=False)
    return (x - m) / torch.sqrt(v + eps)

def _scatter_add(tgt, idx, src, axis=0):
    return tgt.clone().index_add_(axis, idx, src)

def _segment_sum(src, seg, n):
    out = torch.zeros((n,) + src.shape[1:], dtype=src.dtype)
    return out.index_add_(0, seg, src)

def _pad(x, pw):
    flat = tuple((v for pair in reversed(pw) for v in pair))
    return torch.nn.functional.pad(x, flat)
kernel_name = 'standalone__autoregressive_conv_wavernn__speech'

def setup_inputs():

    _w = lambda a: (lambda t: t.to(torch.bfloat16) if t.is_floating_point() else t)(torch.as_tensor(a))
    B, T, D, K = (2, 1000, 256, 15)
    return {'x': _w((lambda *s: torch.randn(*s, dtype=torch.bfloat16) * 0.05)(B, T, D)), 'w': _w((lambda *s: torch.randn(*s, dtype=torch.bfloat16) * 0.05)(K, D, 2 * D))}

def reference(x, w):
    B, T, D = x.shape
    K = w.shape[0]
    dil = 2
    pad = (K - 1) * dil
    xp = _pad(x, ((0, 0), (pad, 0), (0, 0)))
    h = torch.einsum('btd,de->bte', xp[:, 0:T, :], w[0])
    for i in range(1, K):
        h = h + torch.einsum('btd,de->bte', xp[:, i * dil:i * dil + T, :], w[i])
    f, g = (h[..., :D].clone(), h[..., D:].clone())
    return torch.tanh(f) * _sigmoid(g)
```

```asm
; @launch grid=(256,1,1) block=(256,1,1) lds=163840
.amdgcn_target "amdgcn-amd-amdhsa--gfx950"
.text
.globl standalone__autoregressive_conv_wavernn__speech_kernel
.p2align 12
.p2align 8
.type standalone__autoregressive_conv_wavernn__speech_kernel,@function
standalone__autoregressive_conv_wavernn__speech_kernel:
s_load_dwordx4 s[4:7], s[0:1], 0
s_load_dwordx2 s[16:17], s[0:1], 16
s_load_dwordx2 s[20:21], s[0:1], 32
s_cmp_ge_u32 s2, 256
s_cbranch_scc1 L_end
v_lshrrev_b32 v77, 6, v0
v_and_b32 v58, 63, v0
v_readfirstlane_b32 s24, v77
s_getpc_b64 s[30:31]
s_lshr_b32 s3, s2, 3
v_lshl_add_u32 v72, s3, 2, v77
v_min_u32 v72, 77, v72
v_lshlrev_b32 v72, 7, v72
v_mov_b32 v73, s31
v_add_co_u32 v72, vcc, s30, v72
s_bfe_u32 s38, s2, 0x10001
s_and_b32 s47, s2, 1
v_addc_co_u32 v73, vcc, 0, v73, vcc
global_load_dword v57, v[72:73], off
s_and_b32 s25, s2, 3
s_bfe_u32 s42, s2, 0x20004
s_mul_i32 s42, s42, 125
s_sub_u32 s42, s42, s25
s_bfe_u32 s3, s2, 0x10006
s_lshl1_add_u32 s42, s42, s3
s_lshl_b32 s42, s42, 9
s_lshr_b32 s39, s2, 7
s_mul_i32 s39, s39, 512000
s_lshl_b32 s27, s24, 10
s_lshl_b32 s3, s38, 8
s_add_u32 s3, s3, s42
s_add_u32 s3, s3, s27
s_sub_u32 s46, s3, 14336
v_lshrrev_b32 v72, 3, v58
v_and_b32 v76, 7, v0
v_and_b32 v73, 6, v72
v_xor_b32 v73, v73, v76
v_lshl_add_u32 v73, v73, 4, s46
v_lshl_add_u32 v40, v72, 13, v73
v_add_u32 v74, 6, v72
v_and_b32 v73, 6, v74
v_xor_b32 v73, v73, v76
s_add_u32 s3, s46, 4096
v_lshl_add_u32 v73, v73, 4, s3
v_lshl_add_u32 v43, v74, 13, v73
v_cmp_gt_u32 vcc, 2, v72
v_add_u32 v73, 0x20000, v40
v_add_u32 v74, 0xffff0000, v43
v_cndmask_b32 v42, v74, v73, vcc
v_add_u32 v41, 0x10000, v40
v_cmp_gt_u32 vcc, 4, v72
v_add_u32 v44, 0x10000, v43
v_mov_b32 v77, 2147483632
v_cndmask_b32 v44, v77, v44, vcc
s_mul_i32 s26, s24, 5120
s_mul_i32 s37, s24, 3072
s_lshl_b32 s41, s38, 8
s_add_u32 s41, s41, s47
s_bfe_u32 s3, s2, 0x10002
s_bfe_u32 s29, s2, 0x10003
s_lshl1_add_u32 s40, s3, s29
s_lshl2_add_u32 s41, s41, s40
s_lshl_b32 s41, s41, 7
s_lshl_b32 s3, s24, 13
s_add_u32 s41, s41, s3
s_and_b32 s3, s24, 1
s_lshl_b32 s3, s3, 2
v_and_or_b32 v73, v72, 2, s3
v_xor_b32 v73, v73, v76
v_lshl_add_u32 v73, v73, 4, s41
v_lshl_add_u32 v45, v72, 10, v73
s_mov_b32 s10, 512000
s_mov_b32 s11, 0x20000
s_mov_b32 s14, 3932160
s_mov_b32 s15, 0x20000
s_lshr_b32 s28, s2, 4
s_lshl_b32 s28, s28, 18
s_add_u32 s28, s28, s41
s_mul_i32 s29, s29, 3968
s_add_u32 s28, s28, s29
v_and_b32 v75, 1, v76
v_lshl_add_u32 v75, v75, 7, s28
v_lshrrev_b32 v74, 1, v76
v_lshl_add_u32 v75, v74, 10, v75
v_lshl_add_u32 v75, v72, 15, v75
v_cmp_gt_u32 vcc, 1, v72
v_add_u32 v80, 0, v75
s_nop 0
v_cndmask_b32 v80, v77, v80, vcc
v_cmp_gt_u32 vcc, 3, v72
v_add_u32 v81, 32768, v75
s_nop 0
v_cndmask_b32 v81, v77, v81, vcc
v_and_b32 v72, 15, v58
v_lshrrev_b32 v73, 4, v58
v_and_b32 v75, 6, v72
v_xor_b32 v75, v75, v73
v_lshlrev_b32 v75, 4, v75
v_lshl_add_u32 v32, v72, 7, v75
v_add_u32 v74, 1, v72
v_and_b32 v75, 6, v74
v_xor_b32 v75, v75, v73
v_lshlrev_b32 v75, 4, v75
v_lshl_add_u32 v34, v74, 7, v75
v_add_u32 v74, 2, v72
v_and_b32 v75, 6, v74
v_xor_b32 v75, v75, v73
s_add_u32 m0, s26, 0
s_waitcnt lgkmcnt(0)
s_add_u32 s8, s4, s39
s_addc_u32 s9, s5, 0
s_mov_b32 s12, s6
s_mov_b32 s13, s7
buffer_load_dwordx4 v40, s[8:11], 0 offen lds
v_add_u32 v40, 128, v40
s_add_u32 s48, s12, 0
s_addc_u32 s49, s13, 0
s_add_u32 s50, s12, 261120
s_addc_u32 s51, s13, 0
v_lshlrev_b32 v75, 4, v75
v_lshl_add_u32 v36, v74, 7, v75
v_lshrrev_b32 v74, 2, v72
s_add_u32 m0, s26, 1024
v_mad_u32_u24 v74, v73, 24, v74
buffer_load_dwordx4 v41, s[8:11], 0 offen lds
v_add_u32 v41, 128, v41
s_add_u32 s52, s12, 522240
s_addc_u32 s53, s13, 0
s_add_u32 s54, s12, 786432
s_addc_u32 s55, s13, 0
v_bfe_u32 v75, v58, 3, 2
v_xor_b32 v75, s24, v75
v_lshlrev_b32 v75, 5, v75
s_add_u32 m0, s26, 2048
v_lshl_add_u32 v75, v74, 7, v75
buffer_load_dwordx4 v42, s[8:11], 0 offen lds
v_add_u32 v42, 128, v42
s_add_u32 s56, s12, 1047552
s_addc_u32 s57, s13, 0
s_add_u32 s58, s12, 1308672
s_addc_u32 s59, s13, 0
v_and_b32 v74, 3, v58
v_lshl_add_u32 v75, v74, 3, v75
v_add_u32 v38, 40960, v75
s_add_u32 m0, s26, 3072
v_add_u32 v39, 102400, v75
buffer_load_dwordx4 v43, s[8:11], 0 offen lds
v_add_u32 v43, 128, v43
s_add_u32 s60, s12, 1572864
s_addc_u32 s61, s13, 0
s_add_u32 s62, s12, 1833984
s_addc_u32 s63, s13, 0
v_xor_b32 v33, 64, v32
v_xor_b32 v35, 64, v34
v_xor_b32 v37, 64, v36
s_add_u32 m0, s26, 4096
v_add_u32 v46, 32768, v45
buffer_load_dwordx4 v44, s[8:11], 0 offen lds
v_add_u32 v44, 128, v44
s_add_u32 s64, s12, 2095104
s_addc_u32 s65, s13, 0
s_add_u32 s66, s12, 2359296
s_addc_u32 s67, s13, 0
v_add_u32 v47, 65536, v45
v_add_u32 v48, 98304, v45
s_add_u32 s16, s16, s39
s_addc_u32 s17, s17, 0
s_add_u32 m0, s37, 40960
s_mov_b32 s18, 512000
global_load_lds_dwordx4 v45, s[48:49] offset:0
s_add_u32 s68, s12, 2620416
s_addc_u32 s69, s13, 0
s_add_u32 s70, s12, 2881536
s_addc_u32 s71, s13, 0
s_mov_b32 s19, 0x20000
s_mov_b32 s22, 0x2000000
s_mov_b32 s23, 0x20000
buffer_load_dword v57, v80, s[12:15], 0 offen
global_load_lds_dwordx4 v45, s[50:51] offset:1024
s_add_u32 s72, s12, 3145728
s_addc_u32 s73, s13, 0
s_add_u32 s74, s12, 3406848
s_addc_u32 s75, s13, 0
s_lshr_b32 s3, s2, 4
s_lshl2_add_u32 s3, s3, s40
s_mul_i32 s4, s3, 640
global_load_lds_dwordx4 v45, s[52:53] offset:2048
s_add_u32 s76, s12, 3667968
s_addc_u32 s77, s13, 0
s_add_u32 s36, s4, 3145728
s_lshl_b32 s3, s3, 14
s_bfe_u32 s7, s2, 131076
s_add_u32 m0, s37, 53248
s_and_b32 s7, s7, 3
global_load_lds_dwordx4 v45, s[54:55] offset:0
s_xor_b32 s5, s25, s7
s_lshl_b32 s5, s5, 12
s_add_u32 s5, s5, s3
global_load_lds_dwordx4 v45, s[56:57] offset:1024
s_add_u32 s3, s3, s27
s_sub_u32 s4, s25, 1
s_and_b32 s4, s4, 3
global_load_lds_dwordx4 v45, s[58:59] offset:2048
s_xor_b32 s4, s4, s7
s_lshl_b32 s4, s4, 12
s_add_u32 s30, s4, s3
s_add_u32 m0, s37, 65536
s_add_u32 s3, s3, 0x100000
global_load_lds_dwordx4 v45, s[60:61] offset:0
s_sub_u32 s4, s25, 2
s_and_b32 s4, s4, 3
s_xor_b32 s4, s4, s7
global_load_lds_dwordx4 v45, s[62:63] offset:1024
s_lshl_b32 s4, s4, 12
s_add_u32 s31, s4, s3
s_add_u32 s3, s3, 0x100000
s_sub_u32 s4, s25, 3
s_and_b32 s4, s4, 3
s_xor_b32 s4, s4, s7
s_lshl_b32 s4, s4, 12
s_add_u32 s32, s4, s3
v_lshlrev_b32 v51, 4, v73
v_lshl_add_u32 v51, v72, 6, v51
v_lshl_add_u32 v75, s24, 2, v73
v_lshl_add_u32 v59, v74, 4, s5
v_lshl_add_u32 v59, v75, 6, v59
v_bfe_u32 v53, v58, 2, 2
v_lshl_add_u32 v59, v53, 10, v59
v_lshl_add_u32 v53, v74, 7, s36
v_xor_b32 v78, v75, v76
v_lshlrev_b32 v78, 4, v78
v_lshl_add_u32 v78, v72, 8, v78
v_and_b32 v79, 7, v75
v_xor_b32 v79, v79, v72
v_lshlrev_b32 v79, 4, v79
v_lshl_add_u32 v79, v75, 8, v79
s_lshl_b32 s3, s40, 7
s_add_u32 s3, s3, s42
s_add_u32 s3, s3, 3072
v_lshl_add_u32 v49, v72, 3, s3
v_lshl_add_u32 v49, v75, 13, v49
s_cmp_eq_u32 s25, 3
s_cselect_b32 s3, 16, 15
v_cmp_gt_u32 vcc, s3, v75
v_add_u32 v50, 4096, v49
v_mov_b32 v54, s36
v_cndmask_b32 v50, v77, v50, vcc
s_lshl_b32 s4, s25, 7
s_add_u32 s4, s4, s36
v_cmp_gt_u32 vcc, 32, v0
v_lshl_add_u32 v52, v58, 2, s4
v_mov_b32 v60, -1
v_mov_b32 v61, -1
v_mov_b32 v62, -1
v_mov_b32 v63, -1
v_cndmask_b32 v52, v77, v52, vcc
s_mov_b32 s3, 0x4038aa3b
s_bitcmp1_b32 s25, 0
s_cselect_b32 s4, 0xbfb8aa3b, s3
s_cselect_b32 s6, 0, 1.0
s_cselect_b32 s38, 1.0, 0
s_mov_b64 exec, 0
s_cmp_eq_u32 s24, 1
s_cbranch_scc1 L_touch1
s_cmp_eq_u32 s24, 2
s_cbranch_scc1 L_touch2
s_cmp_eq_u32 s24, 3
s_cbranch_scc1 L_touch3
s_branch L_touch0
L_touched:
s_mov_b64 exec, -1
global_load_lds_dwordx4 v45, s[64:65] offset:2048
s_add_u32 m0, s37, 77824
s_nop 0
global_load_lds_dwordx4 v45, s[66:67] offset:0
buffer_load_dword v57, v81, s[12:15], 0 offen
s_waitcnt vmcnt(11)
s_barrier
ds_read_b128 a[0:3], v32 offset:0
ds_read_b64_tr_b16 a[100:101], v38 offset:0
ds_read_b64_tr_b16 a[102:103], v38 offset:512
ds_read_b128 a[104:107], v32 offset:5120
ds_read_b128 a[108:111], v32 offset:10240
ds_read_b128 a[112:115], v32 offset:15360
ds_read_b128 a[116:119], v32 offset:2304
ds_read_b128 a[120:123], v32 offset:7424
ds_read_b128 a[124:127], v32 offset:12544
ds_read_b128 a[128:131], v32 offset:17664
s_waitcnt lgkmcnt(7)
v_mfma_f32_16x16x32_bf16 v[0:3], a[100:103], a[0:3], 0
s_waitcnt vmcnt(9)
s_barrier
s_waitcnt lgkmcnt(6)
v_mfma_f32_16x16x32_bf16 v[4:7], a[100:103], a[104:107], 0
ds_read_b64_tr_b16 a[12:13], v38 offset:1024
s_waitcnt lgkmcnt(6)
v_mfma_f32_16x16x32_bf16 v[8:11], a[100:103], a[108:111], 0
ds_read_b64_tr_b16 a[14:15], v38 offset:1536
s_waitcnt lgkmcnt(6)
v_mfma_f32_16x16x32_bf16 v[12:15], a[100:103], a[112:115], 0
s_waitcnt lgkmcnt(5)
v_mfma_f32_16x16x32_bf16 v[16:19], a[100:103], a[116:119], 0
s_waitcnt lgkmcnt(4)
v_mfma_f32_16x16x32_bf16 v[20:23], a[100:103], a[120:123], 0
s_waitcnt lgkmcnt(1)
v_mfma_f32_16x16x32_bf16 v[24:27], a[100:103], a[124:127], 0
ds_read_b128 a[132:135], v34 offset:0
s_waitcnt vmcnt(8) lgkmcnt(1)
v_mfma_f32_16x16x32_bf16 v[28:31], a[100:103], a[128:131], 0
s_barrier
v_mfma_f32_16x16x32_bf16 v[0:3], a[12:15], a[104:107], v[0:3]
ds_read_b64_tr_b16 a[136:137], v38 offset:2048
v_mfma_f32_16x16x32_bf16 v[4:7], a[12:15], a[108:111], v[4:7]
ds_read_b64_tr_b16 a[138:139], v38 offset:2560
v_mfma_f32_16x16x32_bf16 v[8:11], a[12:15], a[112:115], v[8:11]
v_mfma_f32_16x16x32_bf16 v[12:15], a[12:15], a[116:119], v[12:15]
v_mfma_f32_16x16x32_bf16 v[16:19], a[12:15], a[120:123], v[16:19]
v_mfma_f32_16x16x32_bf16 v[20:23], a[12:15], a[124:127], v[20:23]
v_mfma_f32_16x16x32_bf16 v[24:27], a[12:15], a[128:131], v[24:27]
ds_read_b128 a[140:143], v34 offset:5120
s_waitcnt vmcnt(7) lgkmcnt(1)
v_mfma_f32_16x16x32_bf16 v[28:31], a[12:15], a[132:135], v[28:31]
s_barrier
v_mfma_f32_16x16x32_bf16 v[0:3], a[136:139], a[108:111], v[0:3]
ds_read_b64_tr_b16 a[144:145], v38 offset:12288
v_mfma_f32_16x16x32_bf16 v[4:7], a[136:139], a[112:115], v[4:7]
ds_read_b64_tr_b16 a[146:147], v38 offset:12800
v_mfma_f32_16x16x32_bf16 v[8:11], a[136:139], a[116:119], v[8:11]
v_mfma_f32_16x16x32_bf16 v[12:15], a[136:139], a[120:123], v[12:15]
v_mfma_f32_16x16x32_bf16 v[16:19], a[136:139], a[124:127], v[16:19]
ds_read_b128 a[148:151], v34 offset:10240
s_waitcnt vmcnt(5)
v_mfma_f32_16x16x32_bf16 v[20:23], a[136:139], a[128:131], v[20:23]
s_barrier
v_mfma_f32_16x16x32_bf16 v[24:27], a[136:139], a[132:135], v[24:27]
ds_read_b64_tr_b16 a[152:153], v38 offset:13312
s_waitcnt lgkmcnt(2)
v_mfma_f32_16x16x32_bf16 v[28:31], a[136:139], a[140:143], v[28:31]
ds_read_b64_tr_b16 a[154:155], v38 offset:13824
v_mfma_f32_16x16x32_bf16 v[0:3], a[144:147], a[112:115], v[0:3]
global_load_lds_dwordx4 v45, s[68:69] offset:1024
v_mfma_f32_16x16x32_bf16 v[4:7], a[144:147], a[116:119], v[4:7]
ds_read_b64_tr_b16 a[156:157], v38 offset:14336
v_mfma_f32_16x16x32_bf16 v[8:11], a[144:147], a[120:123], v[8:11]
ds_read_b64_tr_b16 a[158:159], v38 offset:14848
v_mfma_f32_16x16x32_bf16 v[12:15], a[144:147], a[124:127], v[12:15]
v_mfma_f32_16x16x32_bf16 v[16:19], a[144:147], a[128:131], v[16:19]
global_load_lds_dwordx4 v45, s[70:71] offset:2048
v_mfma_f32_16x16x32_bf16 v[20:23], a[144:147], a[132:135], v[20:23]
s_add_u32 m0, s37, 90112
v_mfma_f32_16x16x32_bf16 v[24:27], a[144:147], a[140:143], v[24:27]
s_waitcnt lgkmcnt(0)
v_mfma_f32_16x16x32_bf16 v[28:31], a[144:147], a[148:151], v[28:31]
v_mfma_f32_16x16x32_bf16 v[0:3], a[152:155], a[116:119], v[0:3]
global_load_lds_dwordx4 v45, s[72:73] offset:0
v_mfma_f32_16x16x32_bf16 v[0:3], a[156:159], a[120:123], v[0:3]
ds_read_b128 a[160:163], v34 offset:15360
v_mfma_f32_16x16x32_bf16 v[4:7], a[156:159], a[124:127], v[4:7]
ds_read_b128 a[164:167], v34 offset:2304
s_waitcnt vmcnt(6)
v_mfma_f32_16x16x32_bf16 v[4:7], a[152:155], a[120:123], v[4:7]
s_barrier
v_mfma_f32_16x16x32_bf16 v[8:11], a[152:155], a[124:127], v[8:11]
global_load_lds_dwordx4 v45, s[74:75] offset:1024
v_mfma_f32_16x16x32_bf16 v[8:11], a[156:159], a[128:131], v[8:11]
v_mfma_f32_16x16x32_bf16 v[12:15], a[156:159], a[132:135], v[12:15]
ds_read_b64_tr_b16 a[168:169], v38 offset:24576
v_mfma_f32_16x16x32_bf16 v[12:15], a[152:155], a[128:131], v[12:15]
ds_read_b64_tr_b16 a[170:171], v38 offset:25088
v_mfma_f32_16x16x32_bf16 v[16:19], a[152:155], a[132:135], v[16:19]
global_load_lds_dwordx4 v45, s[76:77] offset:2048
v_mfma_f32_16x16x32_bf16 v[16:19], a[156:159], a[140:143], v[16:19]
ds_read_b64_tr_b16 a[16:17], v38 offset:25600
v_mfma_f32_16x16x32_bf16 v[20:23], a[156:159], a[148:151], v[20:23]
ds_read_b64_tr_b16 a[18:19], v38 offset:26112
v_mfma_f32_16x16x32_bf16 v[20:23], a[152:155], a[140:143], v[20:23]
s_add_u32 m0, s37, 102400
s_waitcnt lgkmcnt(2)
v_mfma_f32_16x16x32_bf16 v[24:27], a[152:155], a[148:151], v[24:27]
global_load_lds_dwordx4 v46, s[48:49] offset:0
v_mfma_f32_16x16x32_bf16 v[24:27], a[156:159], a[160:163], v[24:27]
v_mfma_f32_16x16x32_bf16 v[28:31], a[156:159], a[164:167], v[28:31]
v_mfma_f32_16x16x32_bf16 v[28:31], a[152:155], a[160:163], v[28:31]
s_waitcnt lgkmcnt(0)
v_mfma_f32_16x16x32_bf16 v[0:3], a[168:171], a[124:127], v[0:3]
global_load_lds_dwordx4 v46, s[50:51] offset:1024
v_mfma_f32_16x16x32_bf16 v[0:3], a[16:19], a[128:131], v[0:3]
ds_read_b128 a[172:175], v34 offset:7424
v_mfma_f32_16x16x32_bf16 v[4:7], a[16:19], a[132:135], v[4:7]
ds_read_b128 a[176:179], v34 offset:12544
s_waitcnt vmcnt(8)
v_mfma_f32_16x16x32_bf16 v[4:7], a[168:171], a[128:131], v[4:7]
s_barrier
v_mfma_f32_16x16x32_bf16 v[8:11], a[168:171], a[132:135], v[8:11]
global_load_lds_dwordx4 v46, s[52:53] offset:2048
v_mfma_f32_16x16x32_bf16 v[8:11], a[16:19], a[140:143], v[8:11]
s_add_u32 m0, s37, 114688
v_mfma_f32_16x16x32_bf16 v[12:15], a[16:19], a[148:151], v[12:15]
ds_read_b64_tr_b16 a[180:181], v38 offset:26624
v_mfma_f32_16x16x32_bf16 v[12:15], a[168:171], a[140:143], v[12:15]
ds_read_b64_tr_b16 a[182:183], v38 offset:27136
v_mfma_f32_16x16x32_bf16 v[16:19], a[168:171], a[148:151], v[16:19]
ds_read_b64_tr_b16 a[184:185], v38 offset:36864
v_mfma_f32_16x16x32_bf16 v[16:19], a[16:19], a[160:163], v[16:19]
global_load_lds_dwordx4 v46, s[54:55] offset:0
v_mfma_f32_16x16x32_bf16 v[20:23], a[16:19], a[164:167], v[20:23]
ds_read_b64_tr_b16 a[186:187], v38 offset:37376
v_mfma_f32_16x16x32_bf16 v[20:23], a[168:171], a[160:163], v[20:23]
v_mfma_f32_16x16x32_bf16 v[24:27], a[168:171], a[164:167], v[24:27]
s_waitcnt lgkmcnt(1)
v_mfma_f32_16x16x32_bf16 v[24:27], a[16:19], a[172:175], v[24:27]
global_load_lds_dwordx4 v46, s[56:57] offset:1024
v_mfma_f32_16x16x32_bf16 v[28:31], a[16:19], a[176:179], v[28:31]
v_mfma_f32_16x16x32_bf16 v[28:31], a[168:171], a[172:175], v[28:31]
v_mfma_f32_16x16x32_bf16 v[0:3], a[180:183], a[132:135], v[0:3]
s_waitcnt lgkmcnt(0)
v_mfma_f32_16x16x32_bf16 v[0:3], a[184:187], a[140:143], v[0:3]
global_load_lds_dwordx4 v46, s[58:59] offset:2048
v_mfma_f32_16x16x32_bf16 v[4:7], a[184:187], a[148:151], v[4:7]
ds_read_b128 a[188:191], v34 offset:17664
s_add_u32 m0, s37, 126976
v_mfma_f32_16x16x32_bf16 v[4:7], a[180:183], a[140:143], v[4:7]
ds_read_b128 a[192:195], v36 offset:0
s_waitcnt vmcnt(9)
v_mfma_f32_16x16x32_bf16 v[8:11], a[180:183], a[148:151], v[8:11]
s_barrier
v_mfma_f32_16x16x32_bf16 v[8:11], a[184:187], a[160:163], v[8:11]
global_load_lds_dwordx4 v46, s[60:61] offset:0
v_mfma_f32_16x16x32_bf16 v[12:15], a[184:187], a[164:167], v[12:15]
ds_read_b64_tr_b16 a[196:197], v38 offset:37888
s_add_u32 m0, s26, 20480
v_mfma_f32_16x16x32_bf16 v[12:15], a[180:183], a[160:163], v[12:15]
ds_read_b64_tr_b16 a[198:199], v38 offset:38400
v_mfma_f32_16x16x32_bf16 v[16:19], a[180:183], a[164:167], v[16:19]
ds_read_b64_tr_b16 a[200:201], v38 offset:38912
v_mfma_f32_16x16x32_bf16 v[16:19], a[184:187], a[172:175], v[16:19]
buffer_load_dwordx4 v40, s[8:11], 0 offen lds
v_mfma_f32_16x16x32_bf16 v[20:23], a[184:187], a[176:179], v[20:23]
ds_read_b64_tr_b16 a[202:203], v38 offset:39424
v_mfma_f32_16x16x32_bf16 v[20:23], a[180:183], a[172:175], v[20:23]
s_add_u32 m0, s37, 126976
v_mfma_f32_16x16x32_bf16 v[24:27], a[180:183], a[176:179], v[24:27]
s_waitcnt lgkmcnt(1)
v_mfma_f32_16x16x32_bf16 v[24:27], a[184:187], a[188:191], v[24:27]
global_load_lds_dwordx4 v46, s[62:63] offset:1024
v_mfma_f32_16x16x32_bf16 v[28:31], a[184:187], a[192:195], v[28:31]
s_add_u32 m0, s26, 21504
v_mfma_f32_16x16x32_bf16 v[28:31], a[180:183], a[188:191], v[28:31]
v_mfma_f32_16x16x32_bf16 v[0:3], a[196:199], a[148:151], v[0:3]
ds_read_b128 a[204:207], v36 offset:5120
s_waitcnt lgkmcnt(1)
v_mfma_f32_16x16x32_bf16 v[0:3], a[200:203], a[160:163], v[0:3]
buffer_load_dwordx4 v41, s[8:11], 0 offen lds
v_mfma_f32_16x16x32_bf16 v[4:7], a[200:203], a[164:167], v[4:7]
ds_read_b128 a[208:211], v36 offset:10240
s_waitcnt vmcnt(10)
v_mfma_f32_16x16x32_bf16 v[4:7], a[196:199], a[160:163], v[4:7]
s_barrier
v_mfma_f32_16x16x32_bf16 v[8:11], a[196:199], a[164:167], v[8:11]
ds_read_b64_tr_b16 a[20:21], v38 offset:49152
s_add_u32 m0, s37, 126976
v_mfma_f32_16x16x32_bf16 v[8:11], a[200:203], a[172:175], v[8:11]
global_load_lds_dwordx4 v46, s[64:65] offset:2048
v_mfma_f32_16x16x32_bf16 v[12:15], a[200:203], a[176:179], v[12:15]
ds_read_b64_tr_b16 a[22:23], v38 offset:49664
s_add_u32 m0, s26, 22528
v_mfma_f32_16x16x32_bf16 v[12:15], a[196:199], a[172:175], v[12:15]
ds_read_b64_tr_b16 a[212:213], v38 offset:50176
v_mfma_f32_16x16x32_bf16 v[16:19], a[196:199], a[176:179], v[16:19]
ds_read_b64_tr_b16 a[214:215], v38 offset:50688
v_mfma_f32_16x16x32_bf16 v[16:19], a[200:203], a[188:191], v[16:19]
buffer_load_dwordx4 v42, s[8:11], 0 offen lds
v_mfma_f32_16x16x32_bf16 v[20:23], a[200:203], a[192:195], v[20:23]
ds_read_b64_tr_b16 a[216:217], v38 offset:51200
v_mfma_f32_16x16x32_bf16 v[20:23], a[196:199], a[188:191], v[20:23]
ds_read_b64_tr_b16 a[218:219], v38 offset:51712
v_mfma_f32_16x16x32_bf16 v[24:27], a[196:199], a[192:195], v[24:27]
s_add_u32 m0, s37, 139264
s_waitcnt lgkmcnt(2)
v_mfma_f32_16x16x32_bf16 v[24:27], a[200:203], a[204:207], v[24:27]
global_load_lds_dwordx4 v46, s[66:67] offset:0
v_mfma_f32_16x16x32_bf16 v[28:31], a[200:203], a[208:211], v[28:31]
s_add_u32 m0, s26, 23552
v_mfma_f32_16x16x32_bf16 v[28:31], a[196:199], a[204:207], v[28:31]
v_mfma_f32_16x16x32_bf16 v[0:3], a[20:23], a[164:167], v[0:3]
s_waitcnt lgkmcnt(0)
v_mfma_f32_16x16x32_bf16 v[0:3], a[212:215], a[172:175], v[0:3]
buffer_load_dwordx4 v43, s[8:11], 0 offen lds
v_mfma_f32_16x16x32_bf16 v[0:3], a[216:219], a[176:179], v[0:3]
s_add_u32 m0, s37, 139264
v_mfma_f32_16x16x32_bf16 v[4:7], a[216:219], a[188:191], v[4:7]
ds_read_b128 a[220:223], v36 offset:15360
v_mfma_f32_16x16x32_bf16 v[4:7], a[212:215], a[176:179], v[4:7]
ds_read_b128 a[224:227], v36 offset:2304
v_mfma_f32_16x16x32_bf16 v[4:7], a[20:23], a[172:175], v[4:7]
global_load_lds_dwordx4 v46, s[68:69] offset:1024
v_mfma_f32_16x16x32_bf16 v[8:11], a[20:23], a[176:179], v[8:11]
ds_read_b128 a[228:231], v36 offset:7424
s_add_u32 m0, s26, 24576
v_mfma_f32_16x16x32_bf16 v[8:11], a[212:215], a[188:191], v[8:11]
ds_read_b128 a[232:235], v33 offset:0
s_waitcnt vmcnt(12)
v_mfma_f32_16x16x32_bf16 v[8:11], a[216:219], a[192:195], v[8:11]
s_barrier
v_mfma_f32_16x16x32_bf16 v[12:15], a[216:219], a[204:207], v[12:15]
buffer_load_dwordx4 v44, s[8:11], 0 offen lds
v_mfma_f32_16x16x32_bf16 v[12:15], a[212:215], a[192:195], v[12:15]
ds_read_b64_tr_b16 a[236:237], v39 offset:0
s_add_u32 m0, s37, 139264
v_mfma_f32_16x16x32_bf16 v[12:15], a[20:23], a[188:191], v[12:15]
ds_read_b64_tr_b16 a[238:239], v39 offset:512
v_add_u32 v40, s30, v51
v_mfma_f32_16x16x32_bf16 v[16:19], a[20:23], a[192:195], v[16:19]
ds_read_b128 a[240:243], v33 offset:5120
v_add_u32 v41, s31, v51
L_touch0:
s_cbranch_execz L_touched
v_mfma_f32_16x16x32_bf16 v[16:19], a[212:215], a[204:207], v[16:19]
global_load_lds_dwordx4 v46, s[70:71] offset:2048
v_mfma_f32_16x16x32_bf16 v[16:19], a[216:219], a[208:211], v[16:19]
ds_read_b64_tr_b16 a[244:245], v39 offset:1024
s_waitcnt lgkmcnt(3)
v_mfma_f32_16x16x32_bf16 v[20:23], a[216:219], a[220:223], v[20:23]
ds_read_b64_tr_b16 a[246:247], v39 offset:1536
s_add_u32 m0, s37, 151552
v_mfma_f32_16x16x32_bf16 v[20:23], a[212:215], a[208:211], v[20:23]
ds_read_b128 a[248:251], v33 offset:10240
v_add_u32 v42, s32, v51
v_mfma_f32_16x16x32_bf16 v[20:23], a[20:23], a[204:207], v[20:23]
ds_read_b64_tr_b16 a[24:25], v39 offset:2048
v_add_u32 v43, 1048576, v59
v_mfma_f32_16x16x32_bf16 v[24:27], a[20:23], a[208:211], v[24:27]
global_load_lds_dwordx4 v46, s[72:73] offset:0
v_mfma_f32_16x16x32_bf16 v[24:27], a[212:215], a[220:223], v[24:27]
ds_read_b64_tr_b16 a[26:27], v39 offset:2560
v_add_u32 v44, 2097152, v59
v_mfma_f32_16x16x32_bf16 v[24:27], a[216:219], a[224:227], v[24:27]
ds_read_b128 a[252:255], v33 offset:15360
s_lshl_b32 s29, s25, 25
v_mfma_f32_16x16x32_bf16 v[28:31], a[216:219], a[228:231], v[28:31]
v_add_u32 v51, s29, v52
v_mfma_f32_16x16x32_bf16 v[28:31], a[212:215], a[224:227], v[28:31]
global_load_lds_dwordx4 v46, s[74:75] offset:1024
v_mfma_f32_16x16x32_bf16 v[28:31], a[20:23], a[220:223], v[28:31]
s_waitcnt lgkmcnt(1)
v_mfma_f32_16x16x32_bf16 v[0:3], a[236:239], a[232:235], v[0:3]
ds_read_b128 a[28:31], v33 offset:2304
v_mfma_f32_16x16x32_bf16 v[0:3], a[244:247], a[240:243], v[0:3]
ds_read_b128 a[32:35], v33 offset:7424
s_waitcnt lgkmcnt(2)
v_mfma_f32_16x16x32_bf16 v[0:3], a[24:27], a[248:251], v[0:3]
global_load_lds_dwordx4 v46, s[76:77] offset:2048
v_mfma_f32_16x16x32_bf16 v[4:7], a[24:27], a[252:255], v[4:7]
s_add_u32 m0, s37, 40960
v_mfma_f32_16x16x32_bf16 v[4:7], a[244:247], a[248:251], v[4:7]
ds_read_b128 a[36:39], v33 offset:12544
v_mfma_f32_16x16x32_bf16 v[4:7], a[236:239], a[240:243], v[4:7]
ds_read_b128 a[40:43], v33 offset:17664
v_mfma_f32_16x16x32_bf16 v[8:11], a[236:239], a[248:251], v[8:11]
global_load_lds_dwordx4 v47, s[48:49] offset:0
v_mfma_f32_16x16x32_bf16 v[8:11], a[244:247], a[252:255], v[8:11]
ds_read_b128 a[44:47], v35 offset:0
s_waitcnt lgkmcnt(3)
v_mfma_f32_16x16x32_bf16 v[8:11], a[24:27], a[28:31], v[8:11]
ds_read_b128 a[48:51], v35 offset:5120
s_waitcnt vmcnt(14)
v_mfma_f32_16x16x32_bf16 v[12:15], a[24:27], a[32:35], v[12:15]
s_barrier
v_mfma_f32_16x16x32_bf16 v[12:15], a[244:247], a[28:31], v[12:15]
global_load_lds_dwordx4 v47, s[50:51] offset:1024
v_mfma_f32_16x16x32_bf16 v[12:15], a[236:239], a[252:255], v[12:15]
ds_read_b64_tr_b16 a[4:5], v39 offset:12288
v_mfma_f32_16x16x32_bf16 v[16:19], a[236:239], a[28:31], v[16:19]
ds_read_b64_tr_b16 a[6:7], v39 offset:12800
v_mfma_f32_16x16x32_bf16 v[16:19], a[244:247], a[32:35], v[16:19]
ds_read_b64_tr_b16 a[52:53], v39 offset:13312
s_waitcnt lgkmcnt(3)
v_mfma_f32_16x16x32_bf16 v[16:19], a[24:27], a[36:39], v[16:19]
global_load_lds_dwordx4 v47, s[52:53] offset:2048
v_mfma_f32_16x16x32_bf16 v[20:23], a[24:27], a[40:43], v[20:23]
ds_read_b64_tr_b16 a[54:55], v39 offset:13824
s_add_u32 m0, s37, 53248
v_mfma_f32_16x16x32_bf16 v[20:23], a[244:247], a[36:39], v[20:23]
ds_read_b64_tr_b16 a[56:57], v39 offset:14336
v_mfma_f32_16x16x32_bf16 v[20:23], a[236:239], a[32:35], v[20:23]
ds_read_b64_tr_b16 a[58:59], v39 offset:14848
v_mfma_f32_16x16x32_bf16 v[24:27], a[236:239], a[36:39], v[24:27]
global_load_lds_dwordx4 v47, s[54:55] offset:0
v_mfma_f32_16x16x32_bf16 v[24:27], a[244:247], a[40:43], v[24:27]
ds_read_b64_tr_b16 a[60:61], v39 offset:24576
v_mfma_f32_16x16x32_bf16 v[24:27], a[24:27], a[44:47], v[24:27]
ds_read_b64_tr_b16 a[62:63], v39 offset:25088
v_mfma_f32_16x16x32_bf16 v[28:31], a[24:27], a[48:51], v[28:31]
v_mfma_f32_16x16x32_bf16 v[28:31], a[244:247], a[44:47], v[28:31]
global_load_lds_dwordx4 v47, s[56:57] offset:1024
v_mfma_f32_16x16x32_bf16 v[28:31], a[236:239], a[40:43], v[28:31]
s_waitcnt lgkmcnt(1)
v_mfma_f32_16x16x32_bf16 v[0:3], a[4:7], a[252:255], v[0:3]
v_mfma_f32_16x16x32_bf16 v[0:3], a[52:55], a[28:31], v[0:3]
s_waitcnt lgkmcnt(0)
v_mfma_f32_16x16x32_bf16 v[0:3], a[56:59], a[32:35], v[0:3]
global_load_lds_dwordx4 v47, s[58:59] offset:2048
v_mfma_f32_16x16x32_bf16 v[0:3], a[60:63], a[36:39], v[0:3]
s_add_u32 m0, s37, 65536
v_mfma_f32_16x16x32_bf16 v[4:7], a[60:63], a[40:43], v[4:7]
v_mfma_f32_16x16x32_bf16 v[4:7], a[56:59], a[36:39], v[4:7]
ds_read_b128 a[64:67], v35 offset:10240
v_mfma_f32_16x16x32_bf16 v[4:7], a[52:55], a[32:35], v[4:7]
global_load_lds_dwordx4 v47, s[60:61] offset:0
v_mfma_f32_16x16x32_bf16 v[4:7], a[4:7], a[28:31], v[4:7]
ds_read_b128 a[68:71], v35 offset:15360
v_mfma_f32_16x16x32_bf16 v[8:11], a[4:7], a[32:35], v[8:11]
ds_read_b128 a[72:75], v35 offset:2304
s_waitcnt vmcnt(12)
v_mfma_f32_16x16x32_bf16 v[8:11], a[52:55], a[36:39], v[8:11]
s_barrier
v_mfma_f32_16x16x32_bf16 v[8:11], a[56:59], a[40:43], v[8:11]
global_load_lds_dwordx4 v47, s[62:63] offset:1024
v_mfma_f32_16x16x32_bf16 v[8:11], a[60:63], a[44:47], v[8:11]
ds_read_b64_tr_b16 a[76:77], v39 offset:25600
s_waitcnt lgkmcnt(2)
v_mfma_f32_16x16x32_bf16 v[16:19], a[60:63], a[64:67], v[16:19]
ds_read_b64_tr_b16 a[78:79], v39 offset:26112
v_mfma_f32_16x16x32_bf16 v[16:19], a[56:59], a[48:51], v[16:19]
ds_read_b64_tr_b16 a[80:81], v39 offset:26624
v_mfma_f32_16x16x32_bf16 v[16:19], a[52:55], a[44:47], v[16:19]
global_load_lds_dwordx4 v47, s[64:65] offset:2048
v_mfma_f32_16x16x32_bf16 v[16:19], a[4:7], a[40:43], v[16:19]
ds_read_b64_tr_b16 a[82:83], v39 offset:27136
s_add_u32 m0, s37, 77824
v_mfma_f32_16x16x32_bf16 v[20:23], a[4:7], a[44:47], v[20:23]
ds_read_b64_tr_b16 a[84:85], v39 offset:36864
v_mfma_f32_16x16x32_bf16 v[20:23], a[52:55], a[48:51], v[20:23]
ds_read_b64_tr_b16 a[86:87], v39 offset:37376
v_mfma_f32_16x16x32_bf16 v[20:23], a[56:59], a[64:67], v[20:23]
global_load_lds_dwordx4 v47, s[66:67] offset:0
v_mfma_f32_16x16x32_bf16 v[20:23], a[60:63], a[68:71], v[20:23]
ds_read_b64_tr_b16 a[88:89], v39 offset:37888
s_waitcnt lgkmcnt(3)
v_mfma_f32_16x16x32_bf16 v[24:27], a[60:63], a[72:75], v[24:27]
ds_read_b64_tr_b16 a[90:91], v39 offset:38400
v_mfma_f32_16x16x32_bf16 v[24:27], a[56:59], a[68:71], v[24:27]
v_mfma_f32_16x16x32_bf16 v[24:27], a[52:55], a[64:67], v[24:27]
global_load_lds_dwordx4 v47, s[68:69] offset:1024
v_mfma_f32_16x16x32_bf16 v[24:27], a[4:7], a[48:51], v[24:27]
v_mfma_f32_16x16x32_bf16 v[0:3], a[76:79], a[40:43], v[0:3]
ds_read_b128 a[8:11], v35 offset:12544
v_mfma_f32_16x16x32_bf16 v[0:3], a[80:83], a[44:47], v[0:3]
ds_read_b128 a[92:95], v35 offset:7424
s_waitcnt lgkmcnt(2)
v_mfma_f32_16x16x32_bf16 v[0:3], a[84:87], a[48:51], v[0:3]
ds_read_b128 a[96:99], v35 offset:17664
v_mfma_f32_16x16x32_bf16 v[0:3], a[88:91], a[64:67], v[0:3]
global_load_lds_dwordx4 v47, s[70:71] offset:2048
v_mfma_f32_16x16x32_bf16 v[4:7], a[88:91], a[68:71], v[4:7]
ds_read_b128 v[100:103], v37 offset:0
s_waitcnt vmcnt(12)
v_mfma_f32_16x16x32_bf16 v[4:7], a[84:87], a[64:67], v[4:7]
s_barrier
v_mfma_f32_16x16x32_bf16 v[4:7], a[80:83], a[48:51], v[4:7]
ds_read_b64_tr_b16 v[104:105], v39 offset:38912
s_add_u32 m0, s37, 90112
v_mfma_f32_16x16x32_bf16 v[4:7], a[76:79], a[44:47], v[4:7]
global_load_lds_dwordx4 v47, s[72:73] offset:0
v_mfma_f32_16x16x32_bf16 v[8:11], a[76:79], a[48:51], v[8:11]
ds_read_b64_tr_b16 v[106:107], v39 offset:39424
v_mfma_f32_16x16x32_bf16 v[8:11], a[80:83], a[64:67], v[8:11]
ds_read_b64_tr_b16 v[108:109], v39 offset:49152
v_mfma_f32_16x16x32_bf16 v[8:11], a[84:87], a[68:71], v[8:11]
ds_read_b64_tr_b16 v[110:111], v39 offset:49664
s_waitcnt lgkmcnt(3)
v_mfma_f32_16x16x32_bf16 v[8:11], a[88:91], a[72:75], v[8:11]
global_load_lds_dwordx4 v47, s[74:75] offset:1024
v_mfma_f32_16x16x32_bf16 v[16:19], a[88:91], a[8:11], v[16:19]
ds_read_b64_tr_b16 v[112:113], v39 offset:50176
v_mfma_f32_16x16x32_bf16 v[16:19], a[84:87], a[92:95], v[16:19]
ds_read_b64_tr_b16 v[114:115], v39 offset:50688
v_mfma_f32_16x16x32_bf16 v[16:19], a[80:83], a[72:75], v[16:19]
ds_read_b64_tr_b16 v[116:117], v39 offset:51200
v_mfma_f32_16x16x32_bf16 v[16:19], a[76:79], a[68:71], v[16:19]
global_load_lds_dwordx4 v47, s[76:77] offset:2048
v_mfma_f32_16x16x32_bf16 v[20:23], a[76:79], a[72:75], v[20:23]
ds_read_b64_tr_b16 v[118:119], v39 offset:51712
s_add_u32 m0, s37, 102400
v_mfma_f32_16x16x32_bf16 v[20:23], a[80:83], a[92:95], v[20:23]
ds_read_b128 v[120:123], v37 offset:10240
v_mfma_f32_16x16x32_bf16 v[20:23], a[84:87], a[8:11], v[20:23]
ds_read_b128 v[124:127], v37 offset:5120
v_mfma_f32_16x16x32_bf16 v[20:23], a[88:91], a[96:99], v[20:23]
global_load_lds_dwordx4 v48, s[48:49] offset:0
v_mfma_f32_16x16x32_bf16 v[24:27], a[88:91], v[100:103], v[24:27]
ds_read_b128 v[128:131], v37 offset:15360
v_mfma_f32_16x16x32_bf16 v[24:27], a[84:87], a[96:99], v[24:27]
ds_read_b128 v[132:135], v37 offset:2304
s_waitcnt lgkmcnt(3)
v_mfma_f32_16x16x32_bf16 v[24:27], a[80:83], a[8:11], v[24:27]
s_barrier
v_mfma_f32_16x16x32_bf16 v[24:27], a[76:79], a[92:95], v[24:27]
global_load_lds_dwordx4 v48, s[50:51] offset:1024
v_mfma_f32_16x16x32_bf16 v[0:3], v[104:107], a[68:71], v[0:3]
v_mfma_f32_16x16x32_bf16 v[0:3], v[108:111], a[72:75], v[0:3]
ds_read_b128 v[136:139], v32 offset:20480
s_waitcnt vmcnt(12)
v_mfma_f32_16x16x32_bf16 v[0:3], v[112:115], a[92:95], v[0:3]
s_barrier
v_mfma_f32_16x16x32_bf16 v[0:3], v[116:119], a[8:11], v[0:3]
global_load_lds_dwordx4 v48, s[52:53] offset:2048
v_mfma_f32_16x16x32_bf16 v[4:7], v[116:119], a[96:99], v[4:7]
ds_read_b64_tr_b16 v[140:141], v38 offset:0
s_add_u32 m0, s37, 114688
v_mfma_f32_16x16x32_bf16 v[4:7], v[112:115], a[8:11], v[4:7]
ds_read_b64_tr_b16 v[142:143], v38 offset:512
v_mfma_f32_16x16x32_bf16 v[4:7], v[108:111], a[92:95], v[4:7]
ds_read_b128 v[144:147], v32 offset:25600
v_mfma_f32_16x16x32_bf16 v[4:7], v[104:107], a[72:75], v[4:7]
global_load_lds_dwordx4 v48, s[54:55] offset:0
v_mfma_f32_16x16x32_bf16 v[8:11], v[104:107], a[92:95], v[8:11]
ds_read_b64_tr_b16 v[148:149], v38 offset:1024
v_mfma_f32_16x16x32_bf16 v[8:11], v[108:111], a[8:11], v[8:11]
ds_read_b64_tr_b16 v[150:151], v38 offset:1536
v_mfma_f32_16x16x32_bf16 v[8:11], v[112:115], a[96:99], v[8:11]
ds_read_b128 v[152:155], v32 offset:30720
v_mfma_f32_16x16x32_bf16 v[8:11], v[116:119], v[100:103], v[8:11]
global_load_lds_dwordx4 v48, s[56:57] offset:1024
v_mfma_f32_16x16x32_bf16 v[16:19], v[116:119], v[120:123], v[16:19]
ds_read_b64_tr_b16 v[156:157], v38 offset:2048
s_waitcnt lgkmcnt(3)
v_mfma_f32_16x16x32_bf16 v[16:19], v[112:115], v[124:127], v[16:19]
ds_read_b64_tr_b16 v[158:159], v38 offset:2560
v_mfma_f32_16x16x32_bf16 v[16:19], v[108:111], v[100:103], v[16:19]
ds_read_b128 v[160:163], v32 offset:35840
v_mfma_f32_16x16x32_bf16 v[16:19], v[104:107], a[96:99], v[16:19]
global_load_lds_dwordx4 v48, s[58:59] offset:2048
v_mfma_f32_16x16x32_bf16 v[20:23], v[104:107], v[100:103], v[20:23]
ds_read_b64_tr_b16 v[164:165], v38 offset:12288
s_add_u32 m0, s37, 126976
v_mfma_f32_16x16x32_bf16 v[20:23], v[108:111], v[124:127], v[20:23]
ds_read_b64_tr_b16 v[166:167], v38 offset:12800
v_mfma_f32_16x16x32_bf16 v[20:23], v[112:115], v[120:123], v[20:23]
ds_read_b128 v[168:171], v32 offset:22784
v_mfma_f32_16x16x32_bf16 v[20:23], v[116:119], v[128:131], v[20:23]
global_load_lds_dwordx4 v48, s[60:61] offset:0
v_mfma_f32_16x16x32_bf16 v[24:27], v[116:119], v[132:135], v[24:27]
ds_read_b64_tr_b16 v[172:173], v38 offset:13312
v_mfma_f32_16x16x32_bf16 v[24:27], v[112:115], v[128:131], v[24:27]
ds_read_b64_tr_b16 v[174:175], v38 offset:13824
v_mfma_f32_16x16x32_bf16 v[24:27], v[108:111], v[120:123], v[24:27]
ds_read_b128 v[176:179], v32 offset:27904
v_mfma_f32_16x16x32_bf16 v[24:27], v[104:107], v[124:127], v[24:27]
global_load_lds_dwordx4 v48, s[62:63] offset:1024
v_mfma_f32_16x16x32_bf16 v[0:3], v[140:143], v[136:139], v[0:3]
ds_read_b128 v[180:183], v32 offset:33024
s_waitcnt lgkmcnt(3)
v_mfma_f32_16x16x32_bf16 v[0:3], v[148:151], v[144:147], v[0:3]
ds_read_b128 v[184:187], v34 offset:20480
v_mfma_f32_16x16x32_bf16 v[0:3], v[156:159], v[152:155], v[0:3]
ds_read_b128 v[188:191], v32 offset:38144
s_waitcnt lgkmcnt(3)
v_mfma_f32_16x16x32_bf16 v[0:3], v[164:167], v[160:163], v[0:3]
global_load_lds_dwordx4 v48, s[64:65] offset:2048
v_mfma_f32_16x16x32_bf16 v[0:3], v[172:175], v[168:171], v[0:3]
ds_read_b128 v[192:195], v34 offset:25600
s_add_u32 m0, s37, 139264
v_mfma_f32_16x16x32_bf16 v[4:7], v[172:175], v[176:179], v[4:7]
ds_read_b128 v[196:199], v34 offset:30720
s_waitcnt vmcnt(14)
v_mfma_f32_16x16x32_bf16 v[4:7], v[164:167], v[168:171], v[4:7]
s_barrier
v_mfma_f32_16x16x32_bf16 v[4:7], v[156:159], v[160:163], v[4:7]
global_load_lds_dwordx4 v48, s[66:67] offset:0
v_mfma_f32_16x16x32_bf16 v[4:7], v[148:151], v[152:155], v[4:7]
ds_read_b64_tr_b16 v[200:201], v38 offset:14336
v_mfma_f32_16x16x32_bf16 v[4:7], v[140:143], v[144:147], v[4:7]
ds_read_b64_tr_b16 v[202:203], v38 offset:14848
v_mfma_f32_16x16x32_bf16 v[8:11], v[140:143], v[152:155], v[8:11]
ds_read_b64_tr_b16 v[204:205], v38 offset:24576
v_mfma_f32_16x16x32_bf16 v[8:11], v[148:151], v[160:163], v[8:11]
global_load_lds_dwordx4 v48, s[68:69] offset:1024
v_mfma_f32_16x16x32_bf16 v[8:11], v[156:159], v[168:171], v[8:11]
ds_read_b64_tr_b16 v[206:207], v38 offset:25088
v_mfma_f32_16x16x32_bf16 v[8:11], v[164:167], v[176:179], v[8:11]
ds_read_b64_tr_b16 v[208:209], v38 offset:25600
s_waitcnt lgkmcnt(3)
v_mfma_f32_16x16x32_bf16 v[8:11], v[172:175], v[180:183], v[8:11]
ds_read_b64_tr_b16 v[210:211], v38 offset:26112
v_mfma_f32_16x16x32_bf16 v[16:19], v[172:175], v[184:187], v[16:19]
ds_read_b64_tr_b16 v[212:213], v38 offset:26624
v_mfma_f32_16x16x32_bf16 v[16:19], v[164:167], v[188:191], v[16:19]
global_load_lds_dwordx4 v48, s[70:71] offset:2048
v_mfma_f32_16x16x32_bf16 v[16:19], v[156:159], v[180:183], v[16:19]
ds_read_b64_tr_b16 v[214:215], v38 offset:27136
s_add_u32 m0, s37, 151552
v_mfma_f32_16x16x32_bf16 v[16:19], v[148:151], v[176:179], v[16:19]
ds_read_b64_tr_b16 v[216:217], v38 offset:36864
v_mfma_f32_16x16x32_bf16 v[16:19], v[140:143], v[168:171], v[16:19]
ds_read_b64_tr_b16 v[218:219], v38 offset:37376
v_mfma_f32_16x16x32_bf16 v[20:23], v[140:143], v[176:179], v[20:23]
global_load_lds_dwordx4 v48, s[72:73] offset:0
v_mfma_f32_16x16x32_bf16 v[20:23], v[148:151], v[180:183], v[20:23]
ds_read_b128 v[220:223], v34 offset:35840
v_mfma_f32_16x16x32_bf16 v[20:23], v[156:159], v[188:191], v[20:23]
ds_read_b128 v[224:227], v34 offset:27904
v_mfma_f32_16x16x32_bf16 v[20:23], v[164:167], v[184:187], v[20:23]
ds_read_b128 v[228:231], v34 offset:22784
v_mfma_f32_16x16x32_bf16 v[20:23], v[172:175], v[192:195], v[20:23]
global_load_lds_dwordx4 v48, s[74:75] offset:1024
v_mfma_f32_16x16x32_bf16 v[24:27], v[172:175], v[196:199], v[24:27]
ds_read_b128 v[232:235], v34 offset:33024
v_mfma_f32_16x16x32_bf16 v[24:27], v[164:167], v[192:195], v[24:27]
ds_read_b128 v[236:239], v34 offset:38144
s_waitcnt vmcnt(14)
v_mfma_f32_16x16x32_bf16 v[24:27], v[156:159], v[184:187], v[24:27]
s_barrier
v_mfma_f32_16x16x32_bf16 v[24:27], v[148:151], v[188:191], v[24:27]
global_load_lds_dwordx4 v48, s[76:77] offset:2048
v_mfma_f32_16x16x32_bf16 v[24:27], v[140:143], v[180:183], v[24:27]
s_waitcnt lgkmcnt(1)
v_mfma_f32_16x16x32_bf16 v[0:3], v[200:203], v[176:179], v[0:3]
buffer_load_dword v54, v54, s[20:23], 0 offen sc1
v_mfma_f32_16x16x32_bf16 v[0:3], v[204:207], v[180:183], v[0:3]
ds_read_b64_tr_b16 v[240:241], v38 offset:37888
v_mfma_f32_16x16x32_bf16 v[0:3], v[208:211], v[188:191], v[0:3]
ds_read_b64_tr_b16 v[242:243], v38 offset:38400
v_mfma_f32_16x16x32_bf16 v[0:3], v[212:215], v[184:187], v[0:3]
ds_read_b64_tr_b16 v[244:245], v38 offset:38912
v_mfma_f32_16x16x32_bf16 v[0:3], v[216:219], v[192:195], v[0:3]
ds_read_b64_tr_b16 v[246:247], v38 offset:39424
v_mfma_f32_16x16x32_bf16 v[4:7], v[216:219], v[196:199], v[4:7]
ds_read_b64_tr_b16 v[248:249], v38 offset:49152
v_mfma_f32_16x16x32_bf16 v[4:7], v[212:215], v[192:195], v[4:7]
ds_read_b64_tr_b16 v[250:251], v38 offset:49664
v_mfma_f32_16x16x32_bf16 v[4:7], v[208:211], v[184:187], v[4:7]
ds_read_b64_tr_b16 v[252:253], v38 offset:50176
v_mfma_f32_16x16x32_bf16 v[4:7], v[204:207], v[188:191], v[4:7]
ds_read_b64_tr_b16 v[254:255], v38 offset:50688
v_mfma_f32_16x16x32_bf16 v[4:7], v[200:203], v[180:183], v[4:7]
ds_read_b64_tr_b16 v[96:97], v38 offset:51200
v_mfma_f32_16x16x32_bf16 v[8:11], v[200:203], v[188:191], v[8:11]
buffer_store_dwordx4 v[60:63], v40, s[20:23], 0 offen offset:0 sc1
v_mfma_f32_16x16x32_bf16 v[8:11], v[204:207], v[184:187], v[8:11]
ds_read_b64_tr_b16 v[98:99], v38 offset:51712
v_mfma_f32_16x16x32_bf16 v[8:11], v[208:211], v[192:195], v[8:11]
ds_read_b128 a[0:3], v36 offset:20480
v_mfma_f32_16x16x32_bf16 v[8:11], v[212:215], v[196:199], v[8:11]
ds_read_b128 a[100:103], v36 offset:30720
v_mfma_f32_16x16x32_bf16 v[8:11], v[216:219], v[220:223], v[8:11]
ds_read_b128 a[104:107], v36 offset:25600
v_mfma_f32_16x16x32_bf16 v[16:19], v[216:219], v[224:227], v[16:19]
buffer_store_dwordx4 v[60:63], v41, s[20:23], 0 offen offset:0 sc1
v_mfma_f32_16x16x32_bf16 v[16:19], v[212:215], v[228:231], v[16:19]
ds_read_b128 a[12:15], v36 offset:35840
v_mfma_f32_16x16x32_bf16 v[16:19], v[208:211], v[220:223], v[16:19]
ds_read_b128 a[108:111], v36 offset:22784
v_mfma_f32_16x16x32_bf16 v[16:19], v[204:207], v[196:199], v[16:19]
ds_read_b128 a[136:139], v33 offset:20480
s_waitcnt vmcnt(13)
v_mfma_f32_16x16x32_bf16 v[16:19], v[200:203], v[192:195], v[16:19]
s_barrier
v_mfma_f32_16x16x32_bf16 v[20:23], v[200:203], v[196:199], v[20:23]
buffer_store_dwordx4 v[60:63], v42, s[20:23], 0 offen offset:0 sc1
v_mfma_f32_16x16x32_bf16 v[20:23], v[204:207], v[220:223], v[20:23]
v_mfma_f32_16x16x32_bf16 v[20:23], v[208:211], v[228:231], v[20:23]
ds_read_b64_tr_b16 a[112:113], v39 offset:0
v_mfma_f32_16x16x32_bf16 v[20:23], v[212:215], v[224:227], v[20:23]
ds_read_b64_tr_b16 a[114:115], v39 offset:512
v_mfma_f32_16x16x32_bf16 v[20:23], v[216:219], v[232:235], v[20:23]
ds_read_b128 a[144:147], v33 offset:25600
s_waitcnt lgkmcnt(3)
v_mfma_f32_16x16x32_bf16 v[24:27], v[216:219], v[236:239], v[24:27]
ds_read_b64_tr_b16 a[116:117], v39 offset:1024
v_mfma_f32_16x16x32_bf16 v[24:27], v[212:215], v[232:235], v[24:27]
ds_read_b64_tr_b16 a[118:119], v39 offset:1536
v_mfma_f32_16x16x32_bf16 v[24:27], v[208:211], v[224:227], v[24:27]
ds_read_b128 a[120:123], v33 offset:30720
v_mfma_f32_16x16x32_bf16 v[24:27], v[204:207], v[228:231], v[24:27]
ds_read_b64_tr_b16 a[156:157], v39 offset:2048
v_mfma_f32_16x16x32_bf16 v[24:27], v[200:203], v[220:223], v[24:27]
ds_read_b64_tr_b16 a[158:159], v39 offset:2560
v_mfma_f32_16x16x32_bf16 v[0:3], v[240:243], v[196:199], v[0:3]
ds_read_b128 a[152:155], v33 offset:35840
v_mfma_f32_16x16x32_bf16 v[0:3], v[244:247], v[220:223], v[0:3]
ds_read_b64_tr_b16 a[124:125], v39 offset:12288
v_mfma_f32_16x16x32_bf16 v[0:3], v[248:251], v[228:231], v[0:3]
ds_read_b64_tr_b16 a[126:127], v39 offset:12800
v_mfma_f32_16x16x32_bf16 v[0:3], v[252:255], v[224:227], v[0:3]
ds_read_b128 a[128:131], v33 offset:22784
v_mfma_f32_16x16x32_bf16 v[0:3], v[96:99], v[232:235], v[0:3]
ds_read_b64_tr_b16 a[16:17], v39 offset:13312
v_mfma_f32_16x16x32_bf16 v[4:7], v[96:99], v[236:239], v[4:7]
ds_read_b64_tr_b16 a[18:19], v39 offset:13824
v_mfma_f32_16x16x32_bf16 v[4:7], v[252:255], v[232:235], v[4:7]
ds_read_b128 a[168:171], v33 offset:27904
s_waitcnt vmcnt(9)
v_mfma_f32_16x16x32_bf16 v[4:7], v[248:251], v[224:227], v[4:7]
s_barrier
v_mfma_f32_16x16x32_bf16 v[4:7], v[244:247], v[228:231], v[4:7]
ds_read_b64_tr_b16 a[132:133], v39 offset:14336
v_mfma_f32_16x16x32_bf16 v[4:7], v[240:243], v[220:223], v[4:7]
ds_read_b64_tr_b16 a[134:135], v39 offset:14848
v_mfma_f32_16x16x32_bf16 v[8:11], v[240:243], v[228:231], v[8:11]
ds_read_b128 a[140:143], v33 offset:33024
v_mfma_f32_16x16x32_bf16 v[8:11], v[244:247], v[224:227], v[8:11]
ds_read_b64_tr_b16 a[184:185], v39 offset:24576
v_mfma_f32_16x16x32_bf16 v[8:11], v[248:251], v[232:235], v[8:11]
ds_read_b64_tr_b16 a[186:187], v39 offset:25088
v_mfma_f32_16x16x32_bf16 v[8:11], v[252:255], v[236:239], v[8:11]
ds_read_b128 a[180:183], v33 offset:38144
v_mfma_f32_16x16x32_bf16 v[8:11], v[96:99], a[0:3], v[8:11]
ds_read_b64_tr_b16 a[148:149], v39 offset:25600
v_mfma_f32_16x16x32_bf16 v[16:19], v[96:99], a[100:103], v[16:19]
ds_read_b64_tr_b16 a[150:151], v39 offset:26112
v_mfma_f32_16x16x32_bf16 v[16:19], v[252:255], a[104:107], v[16:19]
ds_read_b128 a[160:163], v35 offset:20480
v_mfma_f32_16x16x32_bf16 v[16:19], v[248:251], a[0:3], v[16:19]
ds_read_b64_tr_b16 a[200:201], v39 offset:26624
v_mfma_f32_16x16x32_bf16 v[16:19], v[244:247], v[236:239], v[16:19]
ds_read_b64_tr_b16 a[202:203], v39 offset:27136
v_mfma_f32_16x16x32_bf16 v[16:19], v[240:243], v[232:235], v[16:19]
ds_read_b128 a[196:199], v35 offset:25600
v_mfma_f32_16x16x32_bf16 v[20:23], v[240:243], v[236:239], v[20:23]
ds_read_b64_tr_b16 a[164:165], v39 offset:36864
v_mfma_f32_16x16x32_bf16 v[20:23], v[244:247], a[0:3], v[20:23]
ds_read_b64_tr_b16 a[166:167], v39 offset:37376
v_mfma_f32_16x16x32_bf16 v[20:23], v[248:251], a[104:107], v[20:23]
ds_read_b128 a[172:175], v35 offset:30720
s_waitcnt vmcnt(4)
v_mfma_f32_16x16x32_bf16 v[20:23], v[252:255], a[100:103], v[20:23]
s_barrier
v_mfma_f32_16x16x32_bf16 v[20:23], v[96:99], a[12:15], v[20:23]
ds_read_b64_tr_b16 a[176:177], v39 offset:37888
v_mfma_f32_16x16x32_bf16 v[24:27], v[96:99], a[108:111], v[24:27]
ds_read_b64_tr_b16 a[178:179], v39 offset:38400
v_mfma_f32_16x16x32_bf16 v[24:27], v[252:255], a[12:15], v[24:27]
ds_read_b128 a[188:191], v35 offset:35840
v_mfma_f32_16x16x32_bf16 v[24:27], v[248:251], a[100:103], v[24:27]
ds_read_b64_tr_b16 a[192:193], v39 offset:38912
v_mfma_f32_16x16x32_bf16 v[24:27], v[244:247], a[104:107], v[24:27]
ds_read_b64_tr_b16 a[194:195], v39 offset:39424
v_mfma_f32_16x16x32_bf16 v[24:27], v[240:243], a[0:3], v[24:27]
ds_read_b128 a[204:207], v35 offset:22784
s_waitcnt lgkmcnt(4)
v_mfma_f32_16x16x32_bf16 v[0:3], a[112:115], a[136:139], v[0:3]
ds_read_b64_tr_b16 a[208:209], v39 offset:49152
v_mfma_f32_16x16x32_bf16 v[0:3], a[116:119], a[144:147], v[0:3]
ds_read_b64_tr_b16 a[210:211], v39 offset:49664
v_mfma_f32_16x16x32_bf16 v[0:3], a[156:159], a[120:123], v[0:3]
ds_read_b128 a[216:219], v35 offset:27904
v_mfma_f32_16x16x32_bf16 v[0:3], a[124:127], a[152:155], v[0:3]
ds_read_b64_tr_b16 a[228:229], v39 offset:50176
v_mfma_f32_16x16x32_bf16 v[0:3], a[16:19], a[128:131], v[0:3]
ds_read_b64_tr_b16 a[230:231], v39 offset:50688
v_mfma_f32_16x16x32_bf16 v[0:3], a[132:135], a[168:171], v[0:3]
ds_read_b128 a[212:215], v35 offset:33024
v_mfma_f32_16x16x32_bf16 v[0:3], a[184:187], a[140:143], v[0:3]
ds_read_b64_tr_b16 a[224:225], v39 offset:51200
v_mfma_f32_16x16x32_bf16 v[0:3], a[148:151], a[180:183], v[0:3]
ds_read_b64_tr_b16 a[226:227], v39 offset:51712
v_mfma_f32_16x16x32_bf16 v[0:3], a[200:203], a[160:163], v[0:3]
ds_read_b128 a[20:23], v37 offset:30720
v_mfma_f32_16x16x32_bf16 v[0:3], a[164:167], a[196:199], v[0:3]
ds_read_b128 a[220:223], v37 offset:25600
v_mfma_f32_16x16x32_bf16 v[0:3], a[176:179], a[172:175], v[0:3]
ds_read_b128 a[232:235], v37 offset:20480
s_waitcnt lgkmcnt(4)
v_mfma_f32_16x16x32_bf16 v[0:3], a[192:195], a[188:191], v[0:3]
ds_read_b128 a[240:243], v35 offset:38144
v_mfma_f32_16x16x32_bf16 v[0:3], a[208:211], a[204:207], v[0:3]
v_mfma_f32_16x16x32_bf16 v[0:3], a[228:231], a[216:219], v[0:3]
s_waitcnt lgkmcnt(2)
v_mfma_f32_16x16x32_bf16 v[0:3], a[224:227], a[212:215], v[0:3]
s_cmp_le_u32 s25, 0
s_cselect_b64 vcc, -1, 0
v_mfma_f32_16x16x32_bf16 v[16:19], a[224:227], a[20:23], v[16:19]
s_nop 1
v_mfma_f32_16x16x32_bf16 v[16:19], a[228:231], a[220:223], v[16:19]
s_waitcnt lgkmcnt(0)
v_mfma_f32_16x16x32_bf16 v[16:19], a[208:211], a[232:235], v[16:19]
s_nop 1
v_mfma_f32_16x16x32_bf16 v[16:19], a[192:195], a[240:243], v[16:19]
s_waitcnt vmcnt(0)
v_add_u32 v54, 2654435761, v54
v_mfma_f32_16x16x32_bf16 v[16:19], a[176:179], a[212:215], v[16:19]
s_barrier
v_mfma_f32_16x16x32_bf16 v[16:19], a[164:167], a[216:219], v[16:19]
buffer_store_dword v54, v52, s[20:23], 0 offen offset:128 sc1
v_mfma_f32_16x16x32_bf16 v[16:19], a[200:203], a[204:207], v[16:19]
v_mul_f32 v0, s4, v0
v_mul_f32 v1, s4, v1
v_mfma_f32_16x16x32_bf16 v[16:19], a[148:151], a[188:191], v[16:19]
v_mul_f32 v2, s4, v2
v_mul_f32 v3, s4, v3
v_mfma_f32_16x16x32_bf16 v[16:19], a[184:187], a[172:175], v[16:19]
v_cvt_pk_bf16_f32 v0, v0, v1
v_cvt_pk_bf16_f32 v1, v2, v3
v_mfma_f32_16x16x32_bf16 v[16:19], a[132:135], a[196:199], v[16:19]
ds_read_b128 a[248:251], v37 offset:22784
v_min_u32 v0, -2, v0
v_mfma_f32_16x16x32_bf16 v[16:19], a[16:19], a[160:163], v[16:19]
ds_read_b128 a[24:27], v37 offset:35840
v_min_u32 v1, -2, v1
v_mfma_f32_16x16x32_bf16 v[16:19], a[124:127], a[180:183], v[16:19]
ds_read_b128 a[244:247], v37 offset:7424
v_mfma_f32_16x16x32_bf16 v[16:19], a[156:159], a[140:143], v[16:19]
ds_read_b128 a[236:239], v36 offset:27904
v_mfma_f32_16x16x32_bf16 v[16:19], a[116:119], a[168:171], v[16:19]
ds_read_b128 a[252:255], v37 offset:27904
v_mfma_f32_16x16x32_bf16 v[16:19], a[112:115], a[128:131], v[16:19]
s_nop 1
v_mfma_f32_16x16x32_bf16 v[8:11], a[112:115], a[120:123], v[8:11]
s_nop 1
v_mfma_f32_16x16x32_bf16 v[8:11], a[116:119], a[152:155], v[8:11]
s_nop 1
v_mfma_f32_16x16x32_bf16 v[8:11], a[156:159], a[128:131], v[8:11]
v_mul_f32 v16, s4, v16
v_mul_f32 v17, s4, v17
v_mfma_f32_16x16x32_bf16 v[8:11], a[124:127], a[168:171], v[8:11]
v_mul_f32 v18, s4, v18
v_mul_f32 v19, s4, v19
v_mfma_f32_16x16x32_bf16 v[8:11], a[16:19], a[140:143], v[8:11]
v_cvt_pk_bf16_f32 v2, v16, v17
v_cvt_pk_bf16_f32 v3, v18, v19
v_mfma_f32_16x16x32_bf16 v[8:11], a[132:135], a[180:183], v[8:11]
v_min_u32 v2, -2, v2
v_min_u32 v3, -2, v3
v_mfma_f32_16x16x32_bf16 v[8:11], a[184:187], a[160:163], v[8:11]
v_cndmask_b32 v16, v2, v0, vcc
v_cndmask_b32 v17, v3, v1, vcc
v_mfma_f32_16x16x32_bf16 v[8:11], a[148:151], a[196:199], v[8:11]
v_cndmask_b32_dpp v18, v0, v2, vcc row_shl:1 row_mask:0xf bank_mask:0xf bound_ctrl:1
v_cndmask_b32_dpp v19, v1, v3, vcc row_shl:1 row_mask:0xf bank_mask:0xf bound_ctrl:1
v_mfma_f32_16x16x32_bf16 v[8:11], a[200:203], a[172:175], v[8:11]
buffer_store_dwordx4 v[16:19], v40, s[20:23], 0 offen sc1
v_mfma_f32_16x16x32_bf16 v[8:11], a[164:167], a[188:191], v[8:11]
s_waitcnt lgkmcnt(0)
v_mfma_f32_16x16x32_bf16 v[8:11], a[176:179], a[204:207], v[8:11]
v_mfma_f32_16x16x32_bf16 v[8:11], a[192:195], a[216:219], v[8:11]
v_mfma_f32_16x16x32_bf16 v[8:11], a[208:211], a[212:215], v[8:11]
v_mfma_f32_16x16x32_bf16 v[8:11], a[228:231], a[240:243], v[8:11]
v_mfma_f32_16x16x32_bf16 v[8:11], a[224:227], a[232:235], v[8:11]
s_cmp_le_u32 s25, 2
s_cselect_b64 vcc, -1, 0
v_mfma_f32_16x16x32_bf16 v[24:27], a[224:227], a[248:251], v[24:27]
s_nop 1
v_mfma_f32_16x16x32_bf16 v[24:27], a[228:231], a[24:27], v[24:27]
s_nop 1
v_mfma_f32_16x16x32_bf16 v[24:27], a[208:211], a[20:23], v[24:27]
v_mul_f32 v8, s4, v8
v_mul_f32 v9, s4, v9
v_mfma_f32_16x16x32_bf16 v[24:27], a[192:195], a[220:223], v[24:27]
v_mul_f32 v10, s4, v10
v_mul_f32 v11, s4, v11
v_mfma_f32_16x16x32_bf16 v[24:27], a[176:179], a[232:235], v[24:27]
v_cvt_pk_bf16_f32 v8, v8, v9
v_cvt_pk_bf16_f32 v9, v10, v11
v_mfma_f32_16x16x32_bf16 v[24:27], a[164:167], a[240:243], v[24:27]
v_min_u32 v8, -2, v8
v_min_u32 v9, -2, v9
v_mfma_f32_16x16x32_bf16 v[24:27], a[200:203], a[212:215], v[24:27]
v_mfma_f32_16x16x32_bf16 v[24:27], a[148:151], a[216:219], v[24:27]
v_mfma_f32_16x16x32_bf16 v[24:27], a[184:187], a[204:207], v[24:27]
v_mfma_f32_16x16x32_bf16 v[24:27], a[132:135], a[188:191], v[24:27]
v_mfma_f32_16x16x32_bf16 v[24:27], a[16:19], a[172:175], v[24:27]
v_mfma_f32_16x16x32_bf16 v[24:27], a[124:127], a[196:199], v[24:27]
v_mfma_f32_16x16x32_bf16 v[24:27], a[156:159], a[160:163], v[24:27]
v_mfma_f32_16x16x32_bf16 v[24:27], a[116:119], a[180:183], v[24:27]
v_mfma_f32_16x16x32_bf16 v[24:27], a[112:115], a[140:143], v[24:27]
s_nop 0
L_touch1:
s_cbranch_execz L_touched
v_mfma_f32_16x16x32_bf16 v[4:7], a[112:115], a[144:147], v[4:7]
s_nop 1
v_mfma_f32_16x16x32_bf16 v[4:7], a[116:119], a[120:123], v[4:7]
s_nop 1
v_mfma_f32_16x16x32_bf16 v[4:7], a[156:159], a[152:155], v[4:7]
v_mul_f32 v24, s4, v24
v_mul_f32 v25, s4, v25
v_mfma_f32_16x16x32_bf16 v[4:7], a[124:127], a[128:131], v[4:7]
v_mul_f32 v26, s4, v26
v_mul_f32 v27, s4, v27
v_mfma_f32_16x16x32_bf16 v[4:7], a[16:19], a[168:171], v[4:7]
v_cvt_pk_bf16_f32 v10, v24, v25
v_cvt_pk_bf16_f32 v11, v26, v27
v_mfma_f32_16x16x32_bf16 v[4:7], a[132:135], a[140:143], v[4:7]
v_min_u32 v10, -2, v10
v_min_u32 v11, -2, v11
v_mfma_f32_16x16x32_bf16 v[4:7], a[184:187], a[180:183], v[4:7]
v_cndmask_b32 v24, v10, v8, vcc
v_cndmask_b32 v25, v11, v9, vcc
v_mfma_f32_16x16x32_bf16 v[4:7], a[148:151], a[160:163], v[4:7]
v_cndmask_b32_dpp v26, v8, v10, vcc row_shl:1 row_mask:0xf bank_mask:0xf bound_ctrl:1
v_cndmask_b32_dpp v27, v9, v11, vcc row_shl:1 row_mask:0xf bank_mask:0xf bound_ctrl:1
v_mfma_f32_16x16x32_bf16 v[4:7], a[200:203], a[196:199], v[4:7]
buffer_store_dwordx4 v[24:27], v42, s[20:23], 0 offen sc1
v_mfma_f32_16x16x32_bf16 v[4:7], a[164:167], a[172:175], v[4:7]
v_mfma_f32_16x16x32_bf16 v[4:7], a[176:179], a[188:191], v[4:7]
v_mfma_f32_16x16x32_bf16 v[4:7], a[192:195], a[204:207], v[4:7]
v_mfma_f32_16x16x32_bf16 v[4:7], a[208:211], a[216:219], v[4:7]
v_mfma_f32_16x16x32_bf16 v[4:7], a[228:231], a[212:215], v[4:7]
v_mfma_f32_16x16x32_bf16 v[4:7], a[224:227], a[240:243], v[4:7]
s_cmp_le_u32 s25, 1
s_cselect_b64 vcc, -1, 0
v_mfma_f32_16x16x32_bf16 v[20:23], a[224:227], a[24:27], v[20:23]
s_nop 1
v_mfma_f32_16x16x32_bf16 v[20:23], a[228:231], a[20:23], v[20:23]
s_nop 1
v_mfma_f32_16x16x32_bf16 v[20:23], a[208:211], a[220:223], v[20:23]
v_mul_f32 v4, s4, v4
v_mul_f32 v5, s4, v5
v_mfma_f32_16x16x32_bf16 v[20:23], a[192:195], a[232:235], v[20:23]
buffer_load_dword v55, v53, s[20:23], 0 offen offset:128 sc1
v_mfma_f32_16x16x32_bf16 v[20:23], a[176:179], a[240:243], v[20:23]
v_mul_f32 v6, s4, v6
v_mul_f32 v7, s4, v7
v_mfma_f32_16x16x32_bf16 v[20:23], a[164:167], a[212:215], v[20:23]
v_cvt_pk_bf16_f32 v4, v4, v5
v_cvt_pk_bf16_f32 v5, v6, v7
v_mfma_f32_16x16x32_bf16 v[20:23], a[200:203], a[216:219], v[20:23]
v_min_u32 v4, -2, v4
v_min_u32 v5, -2, v5
v_mfma_f32_16x16x32_bf16 v[20:23], a[148:151], a[204:207], v[20:23]
v_mfma_f32_16x16x32_bf16 v[20:23], a[184:187], a[188:191], v[20:23]
v_mfma_f32_16x16x32_bf16 v[20:23], a[132:135], a[172:175], v[20:23]
v_mfma_f32_16x16x32_bf16 v[20:23], a[16:19], a[196:199], v[20:23]
v_mfma_f32_16x16x32_bf16 v[20:23], a[124:127], a[160:163], v[20:23]
v_mfma_f32_16x16x32_bf16 v[20:23], a[156:159], a[180:183], v[20:23]
v_mfma_f32_16x16x32_bf16 v[20:23], a[116:119], a[140:143], v[20:23]
v_mfma_f32_16x16x32_bf16 v[20:23], a[112:115], a[168:171], v[20:23]
s_nop 1
v_mfma_f32_16x16x32_bf16 v[12:15], a[224:227], a[220:223], v[12:15]
s_nop 1
v_mfma_f32_16x16x32_bf16 v[12:15], a[228:231], a[232:235], v[12:15]
s_nop 1
v_mfma_f32_16x16x32_bf16 v[12:15], a[208:211], a[240:243], v[12:15]
v_mul_f32 v20, s4, v20
v_mul_f32 v21, s4, v21
v_mfma_f32_16x16x32_bf16 v[12:15], a[192:195], a[212:215], v[12:15]
v_mul_f32 v22, s4, v22
v_mul_f32 v23, s4, v23
v_mfma_f32_16x16x32_bf16 v[12:15], a[176:179], a[216:219], v[12:15]
v_cvt_pk_bf16_f32 v6, v20, v21
v_cvt_pk_bf16_f32 v7, v22, v23
v_mfma_f32_16x16x32_bf16 v[12:15], a[164:167], a[204:207], v[12:15]
v_min_u32 v6, -2, v6
v_min_u32 v7, -2, v7
v_mfma_f32_16x16x32_bf16 v[12:15], a[200:203], a[188:191], v[12:15]
v_cndmask_b32 v20, v6, v4, vcc
v_cndmask_b32 v21, v7, v5, vcc
v_mfma_f32_16x16x32_bf16 v[12:15], a[148:151], a[172:175], v[12:15]
v_cndmask_b32_dpp v22, v4, v6, vcc row_shl:1 row_mask:0xf bank_mask:0xf bound_ctrl:1
v_cndmask_b32_dpp v23, v5, v7, vcc row_shl:1 row_mask:0xf bank_mask:0xf bound_ctrl:1
v_mfma_f32_16x16x32_bf16 v[12:15], a[184:187], a[196:199], v[12:15]
buffer_store_dwordx4 v[20:23], v41, s[20:23], 0 offen sc1
v_mfma_f32_16x16x32_bf16 v[12:15], a[132:135], a[160:163], v[12:15]
v_mfma_f32_16x16x32_bf16 v[12:15], a[16:19], a[180:183], v[12:15]
v_mfma_f32_16x16x32_bf16 v[12:15], a[124:127], a[140:143], v[12:15]
v_mfma_f32_16x16x32_bf16 v[12:15], a[156:159], a[168:171], v[12:15]
v_mfma_f32_16x16x32_bf16 v[12:15], a[116:119], a[128:131], v[12:15]
v_mfma_f32_16x16x32_bf16 v[12:15], a[112:115], a[152:155], v[12:15]
v_mfma_f32_16x16x32_bf16 v[12:15], v[96:99], a[104:107], v[12:15]
v_mfma_f32_16x16x32_bf16 v[12:15], v[252:255], a[0:3], v[12:15]
v_mfma_f32_16x16x32_bf16 v[12:15], v[248:251], v[236:239], v[12:15]
v_mfma_f32_16x16x32_bf16 v[12:15], v[244:247], v[232:235], v[12:15]
v_mfma_f32_16x16x32_bf16 v[12:15], v[240:243], v[224:227], v[12:15]
v_mfma_f32_16x16x32_bf16 v[12:15], v[216:219], v[228:231], v[12:15]
v_mfma_f32_16x16x32_bf16 v[12:15], v[212:215], v[220:223], v[12:15]
v_mfma_f32_16x16x32_bf16 v[12:15], v[208:211], v[196:199], v[12:15]
v_mfma_f32_16x16x32_bf16 v[12:15], v[204:207], v[192:195], v[12:15]
v_mfma_f32_16x16x32_bf16 v[12:15], v[200:203], v[184:187], v[12:15]
v_mfma_f32_16x16x32_bf16 v[12:15], v[172:175], v[188:191], v[12:15]
v_mfma_f32_16x16x32_bf16 v[12:15], v[164:167], v[180:183], v[12:15]
v_mfma_f32_16x16x32_bf16 v[12:15], v[156:159], v[176:179], v[12:15]
v_mfma_f32_16x16x32_bf16 v[12:15], v[148:151], v[168:171], v[12:15]
v_mfma_f32_16x16x32_bf16 v[12:15], v[140:143], v[160:163], v[12:15]
s_mov_b32 s46, 0
s_waitcnt vmcnt(1)
v_mfma_f32_16x16x32_bf16 v[12:15], v[116:119], v[124:127], v[12:15]
v_cmp_ne_u32 s[40:41], v55, v54
v_mfma_f32_16x16x32_bf16 v[12:15], v[112:115], v[100:103], v[12:15]
buffer_load_dwordx4 v[60:63], v59, s[20:23], 0 offen sc1
v_mfma_f32_16x16x32_bf16 v[12:15], v[108:111], a[96:99], v[12:15]
v_mfma_f32_16x16x32_bf16 v[12:15], v[104:107], a[8:11], v[12:15]
v_mfma_f32_16x16x32_bf16 v[12:15], a[88:91], a[92:95], v[12:15]
v_mfma_f32_16x16x32_bf16 v[12:15], a[84:87], a[72:75], v[12:15]
v_mfma_f32_16x16x32_bf16 v[12:15], a[80:83], a[68:71], v[12:15]
v_mfma_f32_16x16x32_bf16 v[12:15], a[76:79], a[64:67], v[12:15]
v_mfma_f32_16x16x32_bf16 v[12:15], a[60:63], a[48:51], v[12:15]
buffer_load_dwordx4 v[68:71], v44, s[20:23], 0 offen sc1
v_mfma_f32_16x16x32_bf16 v[12:15], a[56:59], a[44:47], v[12:15]
v_mfma_f32_16x16x32_bf16 v[12:15], a[52:55], a[40:43], v[12:15]
v_mfma_f32_16x16x32_bf16 v[12:15], a[4:7], a[36:39], v[12:15]
buffer_load_dword v56, v53, s[20:23], 0 offen offset:128 sc1
v_mfma_f32_16x16x32_bf16 v[28:31], a[4:7], a[64:67], v[28:31]
v_mfma_f32_16x16x32_bf16 v[28:31], a[52:55], a[68:71], v[28:31]
v_mfma_f32_16x16x32_bf16 v[28:31], a[56:59], a[72:75], v[28:31]
v_mfma_f32_16x16x32_bf16 v[28:31], a[60:63], a[92:95], v[28:31]
v_mfma_f32_16x16x32_bf16 v[28:31], a[76:79], a[8:11], v[28:31]
v_mfma_f32_16x16x32_bf16 v[28:31], a[80:83], a[96:99], v[28:31]
v_mfma_f32_16x16x32_bf16 v[28:31], a[84:87], v[100:103], v[28:31]
v_mfma_f32_16x16x32_bf16 v[28:31], a[88:91], v[124:127], v[28:31]
ds_write_b64 v78, v[12:13] offset:40960
v_mfma_f32_16x16x32_bf16 v[28:31], v[104:107], v[120:123], v[28:31]
v_mfma_f32_16x16x32_bf16 v[28:31], v[108:111], v[128:131], v[28:31]
ds_write_b64 v78, v[14:15] offset:40968
v_mfma_f32_16x16x32_bf16 v[28:31], v[112:115], v[132:135], v[28:31]
v_mfma_f32_16x16x32_bf16 v[28:31], v[116:119], a[244:247], v[28:31]
v_mfma_f32_16x16x32_bf16 v[28:31], v[140:143], v[188:191], v[28:31]
v_mfma_f32_16x16x32_bf16 v[28:31], v[148:151], v[184:187], v[28:31]
v_mfma_f32_16x16x32_bf16 v[28:31], v[156:159], v[192:195], v[28:31]
v_mfma_f32_16x16x32_bf16 v[28:31], v[164:167], v[196:199], v[28:31]
v_mfma_f32_16x16x32_bf16 v[28:31], v[172:175], v[220:223], v[28:31]
s_waitcnt lgkmcnt(0)
v_mfma_f32_16x16x32_bf16 v[28:31], v[200:203], v[228:231], v[28:31]
s_barrier
v_mfma_f32_16x16x32_bf16 v[28:31], v[204:207], v[224:227], v[28:31]
ds_read_b128 v[8:11], v79 offset:40960
v_mfma_f32_16x16x32_bf16 v[28:31], v[208:211], v[232:235], v[28:31]
v_mfma_f32_16x16x32_bf16 v[28:31], v[212:215], v[236:239], v[28:31]
v_mfma_f32_16x16x32_bf16 v[28:31], v[216:219], a[0:3], v[28:31]
v_mfma_f32_16x16x32_bf16 v[28:31], v[240:243], a[104:107], v[28:31]
v_mfma_f32_16x16x32_bf16 v[28:31], v[244:247], a[100:103], v[28:31]
v_mfma_f32_16x16x32_bf16 v[28:31], v[248:251], a[12:15], v[28:31]
v_mfma_f32_16x16x32_bf16 v[28:31], v[252:255], a[108:111], v[28:31]
v_mfma_f32_16x16x32_bf16 v[28:31], v[96:99], a[236:239], v[28:31]
buffer_load_dwordx4 v[64:67], v43, s[20:23], 0 offen sc1
v_mfma_f32_16x16x32_bf16 v[28:31], a[112:115], a[180:183], v[28:31]
v_mfma_f32_16x16x32_bf16 v[28:31], a[116:119], a[160:163], v[28:31]
v_mfma_f32_16x16x32_bf16 v[28:31], a[156:159], a[196:199], v[28:31]
s_waitcnt vmcnt(3)
v_max3_u32 v72, v60, v61, v62
v_mfma_f32_16x16x32_bf16 v[28:31], a[124:127], a[172:175], v[28:31]
v_max_u32 v72, v72, v63
v_lshlrev_b32 v80, 16, v60
v_mfma_f32_16x16x32_bf16 v[28:31], a[16:19], a[188:191], v[28:31]
v_and_b32 v81, 0xffff0000, v60
v_lshlrev_b32 v82, 16, v61
v_mfma_f32_16x16x32_bf16 v[28:31], a[132:135], a[204:207], v[28:31]
v_and_b32 v83, 0xffff0000, v61
v_lshlrev_b32 v84, 16, v62
v_mfma_f32_16x16x32_bf16 v[28:31], a[184:187], a[216:219], v[28:31]
v_and_b32 v85, 0xffff0000, v62
v_lshlrev_b32 v86, 16, v63
v_mfma_f32_16x16x32_bf16 v[28:31], a[148:151], a[212:215], v[28:31]
v_and_b32 v87, 0xffff0000, v63
v_mfma_f32_16x16x32_bf16 v[28:31], a[200:203], a[240:243], v[28:31]
v_mfma_f32_16x16x32_bf16 v[28:31], a[164:167], a[232:235], v[28:31]
s_waitcnt vmcnt(1)
v_max3_u32 v72, v72, v68, v69
v_mfma_f32_16x16x32_bf16 v[28:31], a[176:179], a[220:223], v[28:31]
v_max3_u32 v72, v72, v70, v71
v_cmp_eq_u32 vcc, -1, v72
v_mfma_f32_16x16x32_bf16 v[28:31], a[192:195], a[20:23], v[28:31]
s_or_b64 s[40:41], s[40:41], vcc
s_cbranch_scc1 L_again
L_backo:
v_mfma_f32_16x16x32_bf16 v[28:31], a[208:211], a[24:27], v[28:31]
buffer_store_dword v54, v51, s[20:23], 0 offen sc1
v_mfma_f32_16x16x32_bf16 v[28:31], a[228:231], a[248:251], v[28:31]
v_lshlrev_b32 v88, 16, v68
v_and_b32 v89, 0xffff0000, v68
v_mfma_f32_16x16x32_bf16 v[28:31], a[224:227], a[252:255], v[28:31]
v_lshlrev_b32 v90, 16, v69
v_and_b32 v91, 0xffff0000, v69
v_lshlrev_b32 v92, 16, v70
v_and_b32 v93, 0xffff0000, v70
v_lshlrev_b32 v94, 16, v71
v_and_b32 v95, 0xffff0000, v71
v_pk_add_f32 v[80:81], v[80:81], v[88:89]
v_pk_add_f32 v[82:83], v[82:83], v[90:91]
v_pk_add_f32 v[84:85], v[84:85], v[92:93]
ds_write_b64 v78, v[28:29] offset:45056
v_pk_add_f32 v[86:87], v[86:87], v[94:95]
v_exp_f32 v80, v80
v_exp_f32 v81, v81
v_exp_f32 v82, v82
ds_write_b64 v78, v[30:31] offset:45064
s_cmp_lg_u64 s[40:41], 0
s_cbranch_scc1 L_rec
v_exp_f32 v83, v83
v_exp_f32 v84, v84
v_exp_f32 v85, v85
v_exp_f32 v86, v86
v_exp_f32 v87, v87
v_pk_add_f32 v[80:81], 1.0, v[80:81] op_sel_hi:[0,1]
v_pk_add_f32 v[82:83], 1.0, v[82:83] op_sel_hi:[0,1]
v_pk_add_f32 v[84:85], 1.0, v[84:85] op_sel_hi:[0,1]
v_pk_add_f32 v[86:87], 1.0, v[86:87] op_sel_hi:[0,1]
v_rcp_f32 v80, v80
v_rcp_f32 v81, v81
v_rcp_f32 v82, v82
v_rcp_f32 v83, v83
v_rcp_f32 v84, v84
v_rcp_f32 v85, v85
v_rcp_f32 v86, v86
v_rcp_f32 v87, v87
v_pk_fma_f32 v[88:89], v[80:81], -2.0, s[38:39] op_sel_hi:[1,0,0]
v_pk_fma_f32 v[90:91], v[82:83], -2.0, s[38:39] op_sel_hi:[1,0,0]
v_pk_fma_f32 v[92:93], v[84:85], -2.0, s[38:39] op_sel_hi:[1,0,0]
v_pk_fma_f32 v[94:95], v[86:87], -2.0, s[38:39] op_sel_hi:[1,0,0]
v_pk_mul_f32 v[80:81], s[6:7], v[80:81] op_sel_hi:[0,1]
v_pk_mul_f32 v[82:83], s[6:7], v[82:83] op_sel_hi:[0,1]
v_pk_mul_f32 v[84:85], s[6:7], v[84:85] op_sel_hi:[0,1]
v_pk_mul_f32 v[86:87], s[6:7], v[86:87] op_sel_hi:[0,1]
s_waitcnt vmcnt(1)
v_max3_u32 v72, v64, v65, v66
v_max_u32 v72, v72, v67
v_cmp_eq_u32 vcc, -1, v72
s_cbranch_vccnz L_slows
L_backs:
v_lshlrev_b32 v0, 16, v64
v_and_b32 v1, 0xffff0000, v64
v_lshlrev_b32 v2, 16, v65
v_and_b32 v3, 0xffff0000, v65
v_lshlrev_b32 v4, 16, v66
v_and_b32 v5, 0xffff0000, v66
v_lshlrev_b32 v6, 16, v67
v_and_b32 v7, 0xffff0000, v67
s_waitcnt lgkmcnt(0)
s_barrier
ds_read_b128 v[12:15], v79 offset:45056
v_pk_fma_f32 v[8:9], v[8:9], s[4:5], v[0:1] op_sel_hi:[1,0,1]
v_pk_fma_f32 v[10:11], v[10:11], s[4:5], v[2:3] op_sel_hi:[1,0,1]
v_exp_f32 v8, v8
v_exp_f32 v9, v9
v_exp_f32 v10, v10
v_exp_f32 v11, v11
v_pk_add_f32 v[8:9], 1.0, v[8:9] op_sel_hi:[0,1]
v_pk_add_f32 v[10:11], 1.0, v[10:11] op_sel_hi:[0,1]
v_rcp_f32 v8, v8
v_rcp_f32 v9, v9
v_rcp_f32 v10, v10
v_rcp_f32 v11, v11
s_waitcnt lgkmcnt(0)
v_pk_fma_f32 v[12:13], v[12:13], s[4:5], v[4:5] op_sel_hi:[1,0,1]
v_pk_fma_f32 v[14:15], v[14:15], s[4:5], v[6:7] op_sel_hi:[1,0,1]
v_pk_fma_f32 v[8:9], v[8:9], v[88:89], v[80:81]
v_pk_fma_f32 v[10:11], v[10:11], v[90:91], v[82:83]
v_cvt_pk_bf16_f32 v0, v8, v9
v_cvt_pk_bf16_f32 v1, v10, v11
buffer_store_dwordx2 v[0:1], v49, s[16:19], 0 offen sc1 nt
v_exp_f32 v12, v12
v_exp_f32 v13, v13
v_exp_f32 v14, v14
v_exp_f32 v15, v15
v_pk_add_f32 v[12:13], 1.0, v[12:13] op_sel_hi:[0,1]
v_pk_add_f32 v[14:15], 1.0, v[14:15] op_sel_hi:[0,1]
v_rcp_f32 v12, v12
v_rcp_f32 v13, v13
v_rcp_f32 v14, v14
v_rcp_f32 v15, v15
v_pk_fma_f32 v[12:13], v[12:13], v[92:93], v[84:85]
v_pk_fma_f32 v[14:15], v[14:15], v[94:95], v[86:87]
v_cvt_pk_bf16_f32 v2, v12, v13
v_cvt_pk_bf16_f32 v3, v14, v15
buffer_store_dwordx2 v[2:3], v50, s[16:19], 0 offen sc1 nt
L_end:
s_endpgm
L_touch2:
s_branch L_touched
L_again:
v_cmp_ne_u32 vcc, v56, v54
s_cbranch_vccz L_again1
buffer_load_dword v56, v53, s[20:23], 0 offen offset:128 sc1
s_add_u32 s46, s46, 1
s_cmp_gt_u32 s46, 200000
s_cbranch_scc1 L_end
s_waitcnt vmcnt(0)
s_branch L_again
L_again1:
buffer_load_dwordx4 v[60:63], v59, s[20:23], 0 offen sc1
buffer_load_dwordx4 v[68:71], v44, s[20:23], 0 offen sc1
buffer_load_dwordx4 v[64:67], v43, s[20:23], 0 offen sc1
s_branch L_backo
L_rec:
s_waitcnt vmcnt(2)
L_rec2:
v_max3_u32 v72, v60, v61, v62
v_max_u32 v72, v72, v63
v_max3_u32 v72, v72, v68, v69
v_max3_u32 v72, v72, v70, v71
v_cmp_eq_u32 vcc, -1, v72
s_cbranch_vccnz L_rec1
buffer_load_dwordx4 v[64:67], v43, s[20:23], 0 offen sc1
v_lshlrev_b32 v80, 16, v60
v_and_b32 v81, 0xffff0000, v60
v_lshlrev_b32 v82, 16, v61
v_and_b32 v83, 0xffff0000, v61
v_lshlrev_b32 v84, 16, v62
v_and_b32 v85, 0xffff0000, v62
v_lshlrev_b32 v86, 16, v63
v_and_b32 v87, 0xffff0000, v63
v_lshlrev_b32 v88, 16, v68
v_and_b32 v89, 0xffff0000, v68
v_lshlrev_b32 v90, 16, v69
v_and_b32 v91, 0xffff0000, v69
v_lshlrev_b32 v92, 16, v70
v_and_b32 v93, 0xffff0000, v70
v_lshlrev_b32 v94, 16, v71
v_and_b32 v95, 0xffff0000, v71
v_pk_add_f32 v[80:81], v[80:81], v[88:89]
v_pk_add_f32 v[82:83], v[82:83], v[90:91]
v_pk_add_f32 v[84:85], v[84:85], v[92:93]
v_pk_add_f32 v[86:87], v[86:87], v[94:95]
v_exp_f32 v80, v80
v_exp_f32 v81, v81
v_exp_f32 v82, v82
v_exp_f32 v83, v83
v_exp_f32 v84, v84
v_exp_f32 v85, v85
v_exp_f32 v86, v86
v_exp_f32 v87, v87
v_pk_add_f32 v[80:81], 1.0, v[80:81] op_sel_hi:[0,1]
v_pk_add_f32 v[82:83], 1.0, v[82:83] op_sel_hi:[0,1]
v_pk_add_f32 v[84:85], 1.0, v[84:85] op_sel_hi:[0,1]
v_pk_add_f32 v[86:87], 1.0, v[86:87] op_sel_hi:[0,1]
v_rcp_f32 v80, v80
v_rcp_f32 v81, v81
v_rcp_f32 v82, v82
v_rcp_f32 v83, v83
v_rcp_f32 v84, v84
v_rcp_f32 v85, v85
v_rcp_f32 v86, v86
v_rcp_f32 v87, v87
v_pk_fma_f32 v[88:89], v[80:81], -2.0, s[38:39] op_sel_hi:[1,0,0]
v_pk_fma_f32 v[90:91], v[82:83], -2.0, s[38:39] op_sel_hi:[1,0,0]
v_pk_fma_f32 v[92:93], v[84:85], -2.0, s[38:39] op_sel_hi:[1,0,0]
v_pk_fma_f32 v[94:95], v[86:87], -2.0, s[38:39] op_sel_hi:[1,0,0]
v_pk_mul_f32 v[80:81], s[6:7], v[80:81] op_sel_hi:[0,1]
v_pk_mul_f32 v[82:83], s[6:7], v[82:83] op_sel_hi:[0,1]
v_pk_mul_f32 v[84:85], s[6:7], v[84:85] op_sel_hi:[0,1]
v_pk_mul_f32 v[86:87], s[6:7], v[86:87] op_sel_hi:[0,1]
s_waitcnt vmcnt(1)
v_max3_u32 v72, v64, v65, v66
v_max_u32 v72, v72, v67
v_cmp_eq_u32 vcc, -1, v72
s_cbranch_vccz L_backs
s_branch L_slows2
L_touch3:
s_branch L_touched
L_rec1:
buffer_load_dwordx4 v[60:63], v59, s[20:23], 0 offen sc1
buffer_load_dwordx4 v[68:71], v44, s[20:23], 0 offen sc1
s_add_u32 s46, s46, 1
s_cmp_gt_u32 s46, 200000
s_cbranch_scc1 L_end
s_waitcnt vmcnt(0)
s_branch L_rec2
L_slows:
buffer_load_dwordx4 v[64:67], v43, s[20:23], 0 offen sc1
s_add_u32 s46, s46, 1
s_cmp_gt_u32 s46, 200000
s_cbranch_scc1 L_end
L_slows2:
s_waitcnt vmcnt(0)
v_max3_u32 v72, v64, v65, v66
v_max_u32 v72, v72, v67
v_cmp_eq_u32 vcc, -1, v72
s_cbranch_vccnz L_slows
s_branch L_backs
.fill 64, 4, 0xbf810000
.section .rodata,"a"
.p2align 6
.amdhsa_kernel standalone__autoregressive_conv_wavernn__speech_kernel
  .amdhsa_next_free_vgpr 512
  .amdhsa_next_free_sgpr 102
  .amdhsa_accum_offset 256
  .amdhsa_group_segment_fixed_size 0
  .amdhsa_kernarg_size 40
  .amdhsa_user_sgpr_count 2
  .amdhsa_user_sgpr_kernarg_segment_ptr 1
  .amdhsa_system_sgpr_workgroup_id_x 1
.end_amdhsa_kernel
```
